```python
import torch

def _softmax(x, axis=-1):
    return torch.softmax(x, dim=axis)
def _gelu(x):
    return torch.nn.functional.gelu(x, approximate="tanh")
def _silu(x):
    return torch.nn.functional.silu(x)
def _sigmoid(x):
    return torch.sigmoid(x)
def _layernorm(x, axis=-1, eps=1e-5):
    m = x.mean(dim=axis, keepdim=True)
    v = x.var(dim=axis, keepdim=True, unbiased=False)
    return (x - m) / torch.sqrt(v + eps)
def _scatter_add(tgt, idx, src, axis=0):
    return tgt.clone().index_add_(axis, idx, src)
def _segment_sum(src, seg, n):
    out = torch.zeros((n,) + src.shape[1:], dtype=src.dtype)
    return out.index_add_(0, seg, src)
def _pad(x, pw):
    flat = tuple(v for pair in reversed(pw) for v in pair)
    return torch.nn.functional.pad(x, flat)

kernel_name = 'gated_mix__gqa_block_cached__gqa_block_cached__decode'

def setup_inputs():

    _w = (lambda a: (lambda t: t.to(torch.bfloat16) if t.is_floating_point() else t)(torch.as_tensor(a)))
    def _A_setup():
        B, Sq, D = 2, 1, 576
        Hq, Hkv, Sk, Dh = 32, 16, 16384, 128
        assert Hq % Hkv == 0, (Hq, Hkv)
        return {
            "x": _w((lambda *s: torch.randn(*s, dtype=torch.bfloat16) * 0.05)(B, Sq, D)),
            "k_cache": _w((lambda *s: torch.randn(*s, dtype=torch.bfloat16) * 6.4)(B, Hkv, Sk, Dh)),
            "v_cache": _w((lambda *s: torch.randn(*s, dtype=torch.bfloat16) * 0.05)(B, Hkv, Sk, Dh)),
            "wq": _w((lambda *s: torch.randn(*s, dtype=torch.bfloat16) * 6.4)(D, Hq * Dh) * (D ** -0.5)),
            "wo": _w((lambda *s: torch.randn(*s, dtype=torch.bfloat16) * 0.05)(Hq * Dh, D) * ((Hq * Dh) ** -0.5)),
        }
    _A_in = _A_setup()

    def _B_setup():
        B, Sq, D = 2, 1, 576
        Hq, Hkv, Sk, Dh = 32, 16, 16384, 128
        assert Hq % Hkv == 0, (Hq, Hkv)
        return {
            "x": _w((lambda *s: torch.randn(*s, dtype=torch.bfloat16) * 0.05)(B, Sq, D)),
            "k_cache": _w((lambda *s: torch.randn(*s, dtype=torch.bfloat16) * 6.4)(B, Hkv, Sk, Dh)),
            "v_cache": _w((lambda *s: torch.randn(*s, dtype=torch.bfloat16) * 0.05)(B, Hkv, Sk, Dh)),
            "wq": _w((lambda *s: torch.randn(*s, dtype=torch.bfloat16) * 6.4)(D, Hq * Dh) * (D ** -0.5)),
            "wo": _w((lambda *s: torch.randn(*s, dtype=torch.bfloat16) * 0.05)(Hq * Dh, D) * ((Hq * Dh) ** -0.5)),
        }
    _B_in = _B_setup()

    return {
        "A_x": _A_in["x"],
        "A_k_cache": _A_in["k_cache"],
        "A_v_cache": _A_in["v_cache"],
        "A_wq": _A_in["wq"],
        "A_wo": _A_in["wo"],
        "B_x": _B_in["x"],
        "B_k_cache": _B_in["k_cache"],
        "B_v_cache": _B_in["v_cache"],
        "B_wq": _B_in["wq"],
        "B_wo": _B_in["wo"],
        "gate_w": _w((lambda *s: torch.randn(*s, dtype=torch.bfloat16) * 0.05)(576) * 16.0),
    }

def reference(A_x, A_k_cache, A_v_cache, A_wq, A_wo, B_x, B_k_cache, B_v_cache, B_wq, B_wo, gate_w):
    def _A_ref(x, k_cache, v_cache, wq, wo):
        B, Sq, D = x.shape
        Hq, Dh = 32, 128
        Hkv = k_cache.shape[1]
        rep = Hq // Hkv
        q = (lambda x, *d: x.permute(*d))((x @ wq).reshape(B, Sq, Hq, Dh), 0, 2, 1, 3)
        k = (lambda x, n, axis: torch.repeat_interleave(x, n, dim=axis))(k_cache, rep, axis=1)
        v = (lambda x, n, axis: torch.repeat_interleave(x, n, dim=axis))(v_cache, rep, axis=1)
        scores = torch.einsum("bhqd,bhkd->bhqk", q, k) * (Dh ** -0.5)
        p = _softmax(scores, axis=-1)
        o = torch.einsum("bhqk,bhkd->bhqd", p, v)
        return (lambda x, *d: x.permute(*d))(o, 0, 2, 1, 3).reshape(B, Sq, Hq * Dh) @ wo

    def _B_ref(x, k_cache, v_cache, wq, wo):
        B, Sq, D = x.shape
        Hq, Dh = 32, 128
        Hkv = k_cache.shape[1]
        rep = Hq // Hkv
        q = (lambda x, *d: x.permute(*d))((x @ wq).reshape(B, Sq, Hq, Dh), 0, 2, 1, 3)
        k = (lambda x, n, axis: torch.repeat_interleave(x, n, dim=axis))(k_cache, rep, axis=1)
        v = (lambda x, n, axis: torch.repeat_interleave(x, n, dim=axis))(v_cache, rep, axis=1)
        scores = torch.einsum("bhqd,bhkd->bhqk", q, k) * (Dh ** -0.5)
        p = _softmax(scores, axis=-1)
        o = torch.einsum("bhqk,bhkd->bhqd", p, v)
        return (lambda x, *d: x.permute(*d))(o, 0, 2, 1, 3).reshape(B, Sq, Hq * Dh) @ wo

    x = A_x
    g = _sigmoid((x * gate_w).sum(-1, keepdims=True))
    a = _A_ref(x, A_k_cache, A_v_cache, A_wq, A_wo)
    b = _B_ref(x, B_k_cache, B_v_cache, B_wq, B_wo)
    return g * a + (1 - g) * b
```

```asm
; @launch grid=(256,1,1) block=(448,1,1) lds=152576
.amdgcn_target "amdgcn-amd-amdhsa--gfx950"
.text
.globl gated_mix__gqa_block_cached__gqa_block_cached__decode_kernel
.p2align 8
.type gated_mix__gqa_block_cached__gqa_block_cached__decode_kernel,@function
gated_mix__gqa_block_cached__gqa_block_cached__decode_kernel:
    s_cmp_ge_u32 s2, 256
    s_cbranch_scc1 L_exit
    s_load_dwordx16 s[4:19], s[0:1], 0
    s_load_dwordx8 s[20:27], s[0:1], 64
    s_load_dwordx2 s[30:31], s[0:1], 104
    v_readfirstlane_b32 s3, v0
    v_and_b32 v0, 63, v0
    s_lshr_b32 s3, s3, 6
    s_bfe_u32 s41, s2, 262147
    s_lshr_b32 s40, s2, 7
    s_and_b32 s45, s2, 7
    s_lshl3_add_u32 s40, s40, s45
    s_mov_b32 s39, 0x20000
    v_and_b32 v1, 15, v0
    v_lshrrev_b32 v2, 4, v0
    s_cmp_eq_u32 s3, 0
    s_cbranch_scc0 L_others
    s_setprio 3
    s_bfe_u32 s54, s41, 131073
    s_mul_i32 s54, s54, 4608
    s_lshl1_add_u32 s54, s40, s54
    s_and_b32 s45, s41, 1
    s_add_u32 s54, s54, s45
    s_lshl_b32 s54, s54, 8
    v_mul_u32_u24 v7, 294912, v2
    v_lshl_add_u32 v7, v1, 4, v7
    s_mov_b32 s51, 8
    s_mov_b32 s38, 4718592
    s_mov_b32 m0, 49152
    s_cmp_ge_u32 s41, 8
    s_waitcnt lgkmcnt(0)
    s_cselect_b64 s[36:37], s[20:21], s[10:11]
L_wq0:
    buffer_load_dwordx4 v7, s[36:39], s54 offen nt lds
    s_addk_i32 m0, 0x400
    s_addk_i32 s54, 0x2000
    buffer_load_dwordx4 v7, s[36:39], s54 offen nt lds
    s_addk_i32 m0, 0x400
    s_addk_i32 s54, 0x2000
    s_sub_u32 s51, s51, 1
    s_cbranch_scc0 L_wq0
    s_branch L_setup
L_others:
    s_cmp_eq_u32 s3, 1
    s_cbranch_scc1 L_helper
    s_getpc_b64 s[98:99]
L_pc:
    s_mul_i32 s45, s41, 5
    s_add_u32 s45, s45, s3
    s_mul_i32 s45, s45, 192
    s_min_u32 s45, s45, L_exit - L_pc - 128 + 192
    s_add_u32 s98, s98, s45
    s_addc_u32 s99, s99, 0
    s_load_dword s97, s[98:99], -192
    s_load_dword s97, s[98:99], -128
    s_load_dword s97, s[98:99], -64
    s_barrier
    s_branch L_roles
L_setup:
    s_mov_b32 s44, 0x1000000
    s_mov_b32 s35, 0x20000
    v_mov_b32 v3, 147456
    v_lshl_add_u32 v4, v0, 2, v3
    v_mov_b32 v9, 0
    ds_write2st64_b32 v4, v9, v9 offset0:0 offset1:19
    s_waitcnt lgkmcnt(0)
    s_barrier
    s_mov_b32 s51, 2
    v_mov_b32 v9, -2
    v_and_b32 v10, 1, v2
    v_mul_u32_u24 v10, 3, v10
    v_lshrrev_b32 v11, 1, v2
    v_xor_b32 v10, v10, v11
    v_lshlrev_b32 v10, 2, v10
    v_xor_b32 v10, v10, v1
    v_lshlrev_b32 v5, 4, v10
    v_bfe_i32 v10, v0, 4, 1
    v_and_b32 v10, 4352, v10
    v_xor_b32 v5, v5, v10
    v_bfe_i32 v10, v0, 5, 1
    v_and_b32 v10, 8704, v10
    v_xor_b32 v5, v5, v10
    s_lshr_b32 s50, s41, 3
    s_lshl_b32 s50, s50, 4
    s_add_u32 s50, s50, s40
    s_lshl_b32 s50, s50, 22
    s_bitcmp1_b32 s41, 0
    s_cselect_b32 s45, 512, 0
    s_xor_b32 s50, s50, s45
    s_bitcmp1_b32 s41, 1
    s_cselect_b32 s45, 1024, 0
    s_xor_b32 s50, s50, s45
    s_bitcmp1_b32 s41, 2
    s_cselect_b32 s45, 2048, 0
    s_xor_b32 s50, s50, s45
    s_and_b32 s45, s50, 111360
    s_xor_b32 s50, s50, s45
    v_xor_b32 v5, s45, v5
    v_xor_b32 v10, 0, v5
    v_add_u32 v20, 4096, v10
    v_xor_b32 v10, 272, v5
    v_add_u32 v21, 3072, v10
    v_xor_b32 v10, 33056, v5
    v_add_u32 v22, 2048, v10
    v_xor_b32 v10, 32816, v5
    v_add_u32 v23, 1024, v10
    v_xor_b32 v10, 66048, v5
    v_add_u32 v24, 4096, v10
    v_xor_b32 v10, 66320, v5
    v_add_u32 v25, 3072, v10
    v_xor_b32 v10, 99104, v5
    v_add_u32 v26, 2048, v10
    v_xor_b32 v10, 98864, v5
    v_add_u32 v27, 1024, v10
    s_sub_u32 s6, s6, 4096
    s_subb_u32 s7, s7, 0
    s_sub_u32 s8, s8, 4096
    s_subb_u32 s9, s9, 0
    s_sub_u32 s16, s16, 4096
    s_subb_u32 s17, s17, 0
    s_sub_u32 s18, s18, 4096
    s_subb_u32 s19, s19, 0
    s_mov_b64 s[32:33], s[6:7]
    s_mov_b32 s34, 134221824
    s_lshl_b32 s55, s40, 1
    s_and_b32 s45, s41, 1
    s_add_u32 s55, s55, s45
    s_mul_i32 s55, s55, 147456
    s_bfe_u32 s45, s41, 131073
    s_mul_i32 s45, s45, 288
    s_add_u32 s55, s55, s45
    v_mov_b32 v8, 72
    v_mov_b32 v10, v0
    s_movk_i32 s46, 3641
    s_movk_i32 s47, 54
L_wq1:
    s_waitcnt vmcnt(19)
    buffer_load_dwordx4 v7, s[36:39], s54 offen nt lds
    s_addk_i32 m0, 0x400
    s_addk_i32 s54, 0x2000
    s_waitcnt vmcnt(19)
    buffer_load_dwordx4 v7, s[36:39], s54 offen nt lds
    s_addk_i32 m0, 0x400
    s_addk_i32 s54, 0x2000
    s_waitcnt vmcnt(19)
    buffer_load_dwordx4 v7, s[36:39], s54 offen nt lds
    s_addk_i32 m0, 0x400
    s_addk_i32 s54, 0x2000
    s_waitcnt vmcnt(19)
    buffer_load_dwordx4 v7, s[36:39], s54 offen nt lds
    s_addk_i32 m0, 0x400
    s_addk_i32 s54, 0x2000
    s_waitcnt vmcnt(19)
    buffer_load_dwordx4 v7, s[36:39], s54 offen nt lds
    s_addk_i32 m0, 0x400
    s_addk_i32 s54, 0x2000
    s_waitcnt vmcnt(19)
    buffer_load_dwordx4 v7, s[36:39], s54 offen nt lds
    s_addk_i32 m0, 0x400
    s_addk_i32 s54, 0x2000
    v_add_u32 v9, 6, v9
    ds_write_b32 v4, v9 offset:4864
    s_sub_u32 s51, s51, 1
    s_cbranch_scc0 L_wq1
    s_cmp_ge_u32 s41, 8
    s_cselect_b64 s[36:37], s[22:23], s[12:13]
    s_mov_b32 s51, 8
L_wo:
    v_mul_u32_u24 v11, s46, v10
    v_lshrrev_b32 v11, 16, v11
    v_mad_u32_u24 v11, v11, s47, v10
    v_lshlrev_b32 v11, 4, v11
    v_add_u32 v10, 64, v10
    s_waitcnt vmcnt(19)
    buffer_load_dwordx4 v11, s[36:39], s55 offen nt lds
    s_addk_i32 m0, 1024
    v_mul_u32_u24 v11, s46, v10
    v_lshrrev_b32 v11, 16, v11
    v_mad_u32_u24 v11, v11, s47, v10
    v_lshlrev_b32 v11, 4, v11
    v_add_u32 v10, 64, v10
    s_waitcnt vmcnt(19)
    buffer_load_dwordx4 v11, s[36:39], s55 offen nt lds
    s_addk_i32 m0, 1024
    v_mul_u32_u24 v11, s46, v10
    v_lshrrev_b32 v11, 16, v11
    v_mad_u32_u24 v11, v11, s47, v10
    v_lshlrev_b32 v11, 4, v11
    v_add_u32 v10, 64, v10
    s_waitcnt vmcnt(19)
    buffer_load_dwordx4 v11, s[36:39], s55 offen nt lds
    s_addk_i32 m0, 1024
    v_mul_u32_u24 v11, s46, v10
    v_lshrrev_b32 v11, 16, v11
    v_mad_u32_u24 v11, v11, s47, v10
    v_lshlrev_b32 v11, 4, v11
    v_add_u32 v10, 64, v10
    s_waitcnt vmcnt(19)
    buffer_load_dwordx4 v11, s[36:39], s55 offen nt lds
    s_addk_i32 m0, 1024
    v_add_u32 v9, 4, v9
    ds_write_b32 v4, v9 offset:4864
    s_sub_u32 s51, s51, 1
    s_cbranch_scc0 L_wo
    s_mov_b32 s51, 0
    s_mov_b32 s52, 0
    s_mov_b32 s53, -2
    s_mov_b32 s58, s50
L_body2:
    s_mov_b32 m0, s52
    s_mov_b32 s54, s58
    s_waitcnt vmcnt(19)
    buffer_load_dwordx4 v20, s[32:35], s54 offen offset:0 nt lds
    s_xor_b32 s57, s54, 17408
    s_add_u32 s51, s51, 1
    s_waitcnt vmcnt(19)
    buffer_load_dwordx4 v21, s[32:35], s54 offen offset:1024 nt lds
    s_bitcmp1_b32 s51, 0
    s_cselect_b32 s55, 132096, 0
    s_xor_b32 s58, s50, s55
    s_waitcnt vmcnt(19)
    buffer_load_dwordx4 v22, s[32:35], s54 offen offset:2048 nt lds
    s_bitcmp1_b32 s51, 1
    s_cselect_b32 s55, 264192, 0
    s_xor_b32 s58, s58, s55
    s_waitcnt vmcnt(19)
    buffer_load_dwordx4 v23, s[32:35], s54 offen offset:3072 nt lds
    v_subrev_u32 v9, 16, v8
    ds_write_b32 v4, v9 offset:4864
    s_bitcmp1_b32 s51, 2
    s_cselect_b32 s55, 541696, 0
    s_xor_b32 s58, s58, s55
    s_addk_i32 m0, 0x1000
    s_waitcnt vmcnt(19)
    buffer_load_dwordx4 v24, s[32:35], s54 offen offset:0 nt lds
    s_bitcmp1_b32 s51, 3
    s_cselect_b32 s55, 1048576, 0
    s_xor_b32 s58, s58, s55
    s_waitcnt vmcnt(19)
    buffer_load_dwordx4 v25, s[32:35], s54 offen offset:1024 nt lds
    s_bitcmp1_b32 s51, 4
    s_cselect_b32 s55, 2097152, 0
    s_xor_b32 s58, s58, s55
    s_waitcnt vmcnt(19)
    buffer_load_dwordx4 v26, s[32:35], s54 offen offset:2048 nt lds
    s_add_u32 s52, s52, 16384
    s_and_b32 s52, s52, 131071
    s_waitcnt vmcnt(19)
    buffer_load_dwordx4 v27, s[32:35], s54 offen offset:3072 nt lds
    v_subrev_u32 v9, 12, v8
    ds_write_b32 v4, v9 offset:4864
    s_addk_i32 m0, 0x1000
    s_waitcnt vmcnt(19)
    buffer_load_dwordx4 v20, s[32:35], s57 offen offset:0 nt lds
    s_add_i32 s53, s53, 1
    s_sub_i32 s46, s53, 4
    s_waitcnt vmcnt(19)
    buffer_load_dwordx4 v21, s[32:35], s57 offen offset:1024 nt lds
    s_max_i32 s46, s46, 1
    s_min_i32 s46, s46, s53
    s_waitcnt vmcnt(19)
    buffer_load_dwordx4 v22, s[32:35], s57 offen offset:2048 nt lds
    s_waitcnt vmcnt(19)
    buffer_load_dwordx4 v23, s[32:35], s57 offen offset:3072 nt lds
    v_subrev_u32 v9, 8, v8
    ds_write_b32 v4, v9 offset:4864
    ds_read_b128 v[12:15], v3 offset:0
    ds_read_b32 v16, v3 offset:68
    s_addk_i32 m0, 0x1000
    s_waitcnt vmcnt(19)
    buffer_load_dwordx4 v24, s[32:35], s57 offen offset:0 nt lds
    s_waitcnt vmcnt(19)
    buffer_load_dwordx4 v25, s[32:35], s57 offen offset:1024 nt lds
    s_waitcnt lgkmcnt(0)
    v_readfirstlane_b32 s56, v16
    v_min3_i32 v12, v12, v13, v14
    v_min_i32 v12, v12, v15
    v_cmp_gt_i32 vcc, s46, v12
    s_waitcnt vmcnt(19)
    buffer_load_dwordx4 v26, s[32:35], s57 offen offset:2048 nt lds
    s_waitcnt vmcnt(19)
    buffer_load_dwordx4 v27, s[32:35], s57 offen offset:3072 nt lds
    v_subrev_u32 v9, 4, v8
    ds_write_b32 v4, v9 offset:4864
    v_add_u32 v8, 16, v8
    s_and_b32 s51, s51, 31
    s_cbranch_scc0 L_phase
    s_cbranch_vccnz L_stall
    s_cmp_le_i32 s56, -2
    s_cbranch_scc1 L_body0
    s_cmp_le_i32 s56, -1
    s_cbranch_scc1 L_body1
    s_cmp_le_i32 s56, 0
    s_cbranch_scc1 L_body2
    s_cmp_le_i32 s56, 1
    s_cbranch_scc1 L_body3
    s_cmp_le_i32 s56, 2
    s_cbranch_scc1 L_body4
    s_cmp_le_i32 s56, 5
    s_cbranch_scc1 L_body5
    s_branch L_body6
L_body0:
    s_mov_b32 m0, s52
    s_mov_b32 s54, s58
    s_waitcnt vmcnt(17)
    buffer_load_dwordx4 v20, s[32:35], s54 offen offset:0 nt lds
    s_xor_b32 s57, s54, 17408
    s_add_u32 s51, s51, 1
    s_waitcnt vmcnt(17)
    buffer_load_dwordx4 v21, s[32:35], s54 offen offset:1024 nt lds
    v_subrev_u32 v9, 16, v8
    ds_write_b32 v4, v9 offset:4864
    s_bitcmp1_b32 s51, 0
    s_cselect_b32 s55, 132096, 0
    s_xor_b32 s58, s50, s55
    s_waitcnt vmcnt(17)
    buffer_load_dwordx4 v22, s[32:35], s54 offen offset:2048 nt lds
    s_bitcmp1_b32 s51, 1
    s_cselect_b32 s55, 264192, 0
    s_xor_b32 s58, s58, s55
    s_waitcnt vmcnt(17)
    buffer_load_dwordx4 v23, s[32:35], s54 offen offset:3072 nt lds
    s_bitcmp1_b32 s51, 2
    s_cselect_b32 s55, 541696, 0
    s_xor_b32 s58, s58, s55
    s_addk_i32 m0, 0x1000
    s_waitcnt vmcnt(17)
    buffer_load_dwordx4 v24, s[32:35], s54 offen offset:0 nt lds
    s_bitcmp1_b32 s51, 3
    s_cselect_b32 s55, 1048576, 0
    s_xor_b32 s58, s58, s55
    s_waitcnt vmcnt(17)
    buffer_load_dwordx4 v25, s[32:35], s54 offen offset:1024 nt lds
    v_subrev_u32 v9, 12, v8
    ds_write_b32 v4, v9 offset:4864
    s_bitcmp1_b32 s51, 4
    s_cselect_b32 s55, 2097152, 0
    s_xor_b32 s58, s58, s55
    s_waitcnt vmcnt(17)
    buffer_load_dwordx4 v26, s[32:35], s54 offen offset:2048 nt lds
    s_add_u32 s52, s52, 16384
    s_and_b32 s52, s52, 131071
    s_waitcnt vmcnt(17)
    buffer_load_dwordx4 v27, s[32:35], s54 offen offset:3072 nt lds
    s_addk_i32 m0, 0x1000
    s_waitcnt vmcnt(17)
    buffer_load_dwordx4 v20, s[32:35], s57 offen offset:0 nt lds
    s_add_i32 s53, s53, 1
    s_sub_i32 s46, s53, 4
    s_waitcnt vmcnt(17)
    buffer_load_dwordx4 v21, s[32:35], s57 offen offset:1024 nt lds
    v_subrev_u32 v9, 8, v8
    ds_write_b32 v4, v9 offset:4864
    s_max_i32 s46, s46, 1
    s_min_i32 s46, s46, s53
    s_waitcnt vmcnt(17)
    buffer_load_dwordx4 v22, s[32:35], s57 offen offset:2048 nt lds
    s_waitcnt vmcnt(17)
    buffer_load_dwordx4 v23, s[32:35], s57 offen offset:3072 nt lds
    ds_read_b128 v[12:15], v3 offset:0
    ds_read_b32 v16, v3 offset:68
    s_addk_i32 m0, 0x1000
    s_waitcnt vmcnt(17)
    buffer_load_dwordx4 v24, s[32:35], s57 offen offset:0 nt lds
    s_waitcnt vmcnt(17)
    buffer_load_dwordx4 v25, s[32:35], s57 offen offset:1024 nt lds
    v_subrev_u32 v9, 4, v8
    ds_write_b32 v4, v9 offset:4864
    s_waitcnt lgkmcnt(1)
    v_readfirstlane_b32 s56, v16
    v_min3_i32 v12, v12, v13, v14
    v_min_i32 v12, v12, v15
    v_cmp_gt_i32 vcc, s46, v12
    s_waitcnt vmcnt(17)
    buffer_load_dwordx4 v26, s[32:35], s57 offen offset:2048 nt lds
    s_waitcnt vmcnt(17)
    buffer_load_dwordx4 v27, s[32:35], s57 offen offset:3072 nt lds
    v_add_u32 v8, 16, v8
    s_and_b32 s51, s51, 31
    s_cbranch_scc0 L_phase
    s_cbranch_vccnz L_stall
    s_cmp_le_i32 s56, -2
    s_cbranch_scc1 L_body0
    s_cmp_le_i32 s56, -1
    s_cbranch_scc1 L_body1
    s_cmp_le_i32 s56, 0
    s_cbranch_scc1 L_body2
    s_cmp_le_i32 s56, 1
    s_cbranch_scc1 L_body3
    s_cmp_le_i32 s56, 2
    s_cbranch_scc1 L_body4
    s_cmp_le_i32 s56, 5
    s_cbranch_scc1 L_body5
    s_branch L_body6
L_body1:
    s_mov_b32 m0, s52
    s_mov_b32 s54, s58
    s_waitcnt vmcnt(18)
    buffer_load_dwordx4 v20, s[32:35], s54 offen offset:0 nt lds
    s_xor_b32 s57, s54, 17408
    s_add_u32 s51, s51, 1
    s_waitcnt vmcnt(18)
    buffer_load_dwordx4 v21, s[32:35], s54 offen offset:1024 nt lds
    s_bitcmp1_b32 s51, 0
    s_cselect_b32 s55, 132096, 0
    s_xor_b32 s58, s50, s55
    s_waitcnt vmcnt(18)
    buffer_load_dwordx4 v22, s[32:35], s54 offen offset:2048 nt lds
    v_subrev_u32 v9, 16, v8
    ds_write_b32 v4, v9 offset:4864
    s_bitcmp1_b32 s51, 1
    s_cselect_b32 s55, 264192, 0
    s_xor_b32 s58, s58, s55
    s_waitcnt vmcnt(18)
    buffer_load_dwordx4 v23, s[32:35], s54 offen offset:3072 nt lds
    s_bitcmp1_b32 s51, 2
    s_cselect_b32 s55, 541696, 0
    s_xor_b32 s58, s58, s55
    s_addk_i32 m0, 0x1000
    s_waitcnt vmcnt(18)
    buffer_load_dwordx4 v24, s[32:35], s54 offen offset:0 nt lds
    s_bitcmp1_b32 s51, 3
    s_cselect_b32 s55, 1048576, 0
    s_xor_b32 s58, s58, s55
    s_waitcnt vmcnt(18)
    buffer_load_dwordx4 v25, s[32:35], s54 offen offset:1024 nt lds
    s_bitcmp1_b32 s51, 4
    s_cselect_b32 s55, 2097152, 0
    s_xor_b32 s58, s58, s55
    s_waitcnt vmcnt(18)
    buffer_load_dwordx4 v26, s[32:35], s54 offen offset:2048 nt lds
    v_subrev_u32 v9, 12, v8
    ds_write_b32 v4, v9 offset:4864
    s_add_u32 s52, s52, 16384
    s_and_b32 s52, s52, 131071
    s_waitcnt vmcnt(18)
    buffer_load_dwordx4 v27, s[32:35], s54 offen offset:3072 nt lds
    s_addk_i32 m0, 0x1000
    s_waitcnt vmcnt(18)
    buffer_load_dwordx4 v20, s[32:35], s57 offen offset:0 nt lds
    s_add_i32 s53, s53, 1
    s_sub_i32 s46, s53, 4
    s_waitcnt vmcnt(18)
    buffer_load_dwordx4 v21, s[32:35], s57 offen offset:1024 nt lds
    s_max_i32 s46, s46, 1
    s_min_i32 s46, s46, s53
    s_waitcnt vmcnt(18)
    buffer_load_dwordx4 v22, s[32:35], s57 offen offset:2048 nt lds
    v_subrev_u32 v9, 8, v8
    ds_write_b32 v4, v9 offset:4864
    s_waitcnt vmcnt(18)
    buffer_load_dwordx4 v23, s[32:35], s57 offen offset:3072 nt lds
    ds_read_b128 v[12:15], v3 offset:0
    ds_read_b32 v16, v3 offset:68
    s_addk_i32 m0, 0x1000
    s_waitcnt vmcnt(18)
    buffer_load_dwordx4 v24, s[32:35], s57 offen offset:0 nt lds
    s_waitcnt vmcnt(18)
    buffer_load_dwordx4 v25, s[32:35], s57 offen offset:1024 nt lds
    s_waitcnt lgkmcnt(0)
    v_readfirstlane_b32 s56, v16
    v_min3_i32 v12, v12, v13, v14
    v_min_i32 v12, v12, v15
    v_cmp_gt_i32 vcc, s46, v12
    s_waitcnt vmcnt(18)
    buffer_load_dwordx4 v26, s[32:35], s57 offen offset:2048 nt lds
    v_subrev_u32 v9, 4, v8
    ds_write_b32 v4, v9 offset:4864
    s_waitcnt vmcnt(18)
    buffer_load_dwordx4 v27, s[32:35], s57 offen offset:3072 nt lds
    v_add_u32 v8, 16, v8
    s_and_b32 s51, s51, 31
    s_cbranch_scc0 L_phase
    s_cbranch_vccnz L_stall
    s_cmp_le_i32 s56, -2
    s_cbranch_scc1 L_body0
    s_cmp_le_i32 s56, -1
    s_cbranch_scc1 L_body1
    s_cmp_le_i32 s56, 0
    s_cbranch_scc1 L_body2
    s_cmp_le_i32 s56, 1
    s_cbranch_scc1 L_body3
    s_cmp_le_i32 s56, 2
    s_cbranch_scc1 L_body4
    s_cmp_le_i32 s56, 5
    s_cbranch_scc1 L_body5
    s_branch L_body6
L_body3:
    s_mov_b32 m0, s52
    s_mov_b32 s54, s58
    s_waitcnt vmcnt(20)
    buffer_load_dwordx4 v20, s[32:35], s54 offen offset:0 nt lds
    v_subrev_u32 v9, 20, v8
    ds_write_b32 v4, v9 offset:4864
    s_xor_b32 s57, s54, 17408
    s_add_u32 s51, s51, 1
    s_waitcnt vmcnt(20)
    buffer_load_dwordx4 v21, s[32:35], s54 offen offset:1024 nt lds
    s_bitcmp1_b32 s51, 0
    s_cselect_b32 s55, 132096, 0
    s_xor_b32 s58, s50, s55
    s_waitcnt vmcnt(20)
    buffer_load_dwordx4 v22, s[32:35], s54 offen offset:2048 nt lds
    s_bitcmp1_b32 s51, 1
    s_cselect_b32 s55, 264192, 0
    s_xor_b32 s58, s58, s55
    s_waitcnt vmcnt(20)
    buffer_load_dwordx4 v23, s[32:35], s54 offen offset:3072 nt lds
    s_bitcmp1_b32 s51, 2
    s_cselect_b32 s55, 541696, 0
    s_xor_b32 s58, s58, s55
    s_addk_i32 m0, 0x1000
    s_waitcnt vmcnt(20)
    buffer_load_dwordx4 v24, s[32:35], s54 offen offset:0 nt lds
    v_subrev_u32 v9, 16, v8
    ds_write_b32 v4, v9 offset:4864
    s_bitcmp1_b32 s51, 3
    s_cselect_b32 s55, 1048576, 0
    s_xor_b32 s58, s58, s55
    s_waitcnt vmcnt(20)
    buffer_load_dwordx4 v25, s[32:35], s54 offen offset:1024 nt lds
    s_bitcmp1_b32 s51, 4
    s_cselect_b32 s55, 2097152, 0
    s_xor_b32 s58, s58, s55
    s_waitcnt vmcnt(20)
    buffer_load_dwordx4 v26, s[32:35], s54 offen offset:2048 nt lds
    s_add_u32 s52, s52, 16384
    s_and_b32 s52, s52, 131071
    s_waitcnt vmcnt(20)
    buffer_load_dwordx4 v27, s[32:35], s54 offen offset:3072 nt lds
    s_addk_i32 m0, 0x1000
    s_waitcnt vmcnt(20)
    buffer_load_dwordx4 v20, s[32:35], s57 offen offset:0 nt lds
    v_subrev_u32 v9, 12, v8
    ds_write_b32 v4, v9 offset:4864
    s_add_i32 s53, s53, 1
    s_sub_i32 s46, s53, 4
    s_waitcnt vmcnt(20)
    buffer_load_dwordx4 v21, s[32:35], s57 offen offset:1024 nt lds
    s_max_i32 s46, s46, 1
    s_min_i32 s46, s46, s53
    s_waitcnt vmcnt(20)
    buffer_load_dwordx4 v22, s[32:35], s57 offen offset:2048 nt lds
    s_waitcnt vmcnt(20)
    buffer_load_dwordx4 v23, s[32:35], s57 offen offset:3072 nt lds
    ds_read_b128 v[12:15], v3 offset:0
    ds_read_b32 v16, v3 offset:68
    s_addk_i32 m0, 0x1000
    s_waitcnt vmcnt(20)
    buffer_load_dwordx4 v24, s[32:35], s57 offen offset:0 nt lds
    v_subrev_u32 v9, 8, v8
    ds_write_b32 v4, v9 offset:4864
    s_waitcnt vmcnt(20)
    buffer_load_dwordx4 v25, s[32:35], s57 offen offset:1024 nt lds
    s_waitcnt lgkmcnt(1)
    v_readfirstlane_b32 s56, v16
    v_min3_i32 v12, v12, v13, v14
    v_min_i32 v12, v12, v15
    v_cmp_gt_i32 vcc, s46, v12
    s_waitcnt vmcnt(20)
    buffer_load_dwordx4 v26, s[32:35], s57 offen offset:2048 nt lds
    s_waitcnt vmcnt(20)
    buffer_load_dwordx4 v27, s[32:35], s57 offen offset:3072 nt lds
    v_add_u32 v8, 16, v8
    s_and_b32 s51, s51, 31
    s_cbranch_scc0 L_phase
    s_cbranch_vccnz L_stall
    s_cmp_le_i32 s56, -2
    s_cbranch_scc1 L_body0
    s_cmp_le_i32 s56, -1
    s_cbranch_scc1 L_body1
    s_cmp_le_i32 s56, 0
    s_cbranch_scc1 L_body2
    s_cmp_le_i32 s56, 1
    s_cbranch_scc1 L_body3
    s_cmp_le_i32 s56, 2
    s_cbranch_scc1 L_body4
    s_cmp_le_i32 s56, 5
    s_cbranch_scc1 L_body5
    s_branch L_body6
L_body4:
    s_mov_b32 m0, s52
    s_mov_b32 s54, s58
    s_waitcnt vmcnt(21)
    buffer_load_dwordx4 v20, s[32:35], s54 offen offset:0 nt lds
    s_xor_b32 s57, s54, 17408
    s_add_u32 s51, s51, 1
    s_waitcnt vmcnt(21)
    buffer_load_dwordx4 v21, s[32:35], s54 offen offset:1024 nt lds
    v_subrev_u32 v9, 20, v8
    ds_write_b32 v4, v9 offset:4864
    s_bitcmp1_b32 s51, 0
    s_cselect_b32 s55, 132096, 0
    s_xor_b32 s58, s50, s55
    s_waitcnt vmcnt(21)
    buffer_load_dwordx4 v22, s[32:35], s54 offen offset:2048 nt lds
    s_bitcmp1_b32 s51, 1
    s_cselect_b32 s55, 264192, 0
    s_xor_b32 s58, s58, s55
    s_waitcnt vmcnt(21)
    buffer_load_dwordx4 v23, s[32:35], s54 offen offset:3072 nt lds
    s_bitcmp1_b32 s51, 2
    s_cselect_b32 s55, 541696, 0
    s_xor_b32 s58, s58, s55
    s_addk_i32 m0, 0x1000
    s_waitcnt vmcnt(21)
    buffer_load_dwordx4 v24, s[32:35], s54 offen offset:0 nt lds
    s_bitcmp1_b32 s51, 3
    s_cselect_b32 s55, 1048576, 0
    s_xor_b32 s58, s58, s55
    s_waitcnt vmcnt(21)
    buffer_load_dwordx4 v25, s[32:35], s54 offen offset:1024 nt lds
    v_subrev_u32 v9, 16, v8
    ds_write_b32 v4, v9 offset:4864
    s_bitcmp1_b32 s51, 4
    s_cselect_b32 s55, 2097152, 0
    s_xor_b32 s58, s58, s55
    s_waitcnt vmcnt(21)
    buffer_load_dwordx4 v26, s[32:35], s54 offen offset:2048 nt lds
    s_add_u32 s52, s52, 16384
    s_and_b32 s52, s52, 131071
    s_waitcnt vmcnt(21)
    buffer_load_dwordx4 v27, s[32:35], s54 offen offset:3072 nt lds
    s_addk_i32 m0, 0x1000
    s_waitcnt vmcnt(21)
    buffer_load_dwordx4 v20, s[32:35], s57 offen offset:0 nt lds
    s_add_i32 s53, s53, 1
    s_sub_i32 s46, s53, 4
    s_waitcnt vmcnt(21)
    buffer_load_dwordx4 v21, s[32:35], s57 offen offset:1024 nt lds
    v_subrev_u32 v9, 12, v8
    ds_write_b32 v4, v9 offset:4864
    s_max_i32 s46, s46, 1
    s_min_i32 s46, s46, s53
    s_waitcnt vmcnt(21)
    buffer_load_dwordx4 v22, s[32:35], s57 offen offset:2048 nt lds
    s_waitcnt vmcnt(21)
    buffer_load_dwordx4 v23, s[32:35], s57 offen offset:3072 nt lds
    ds_read_b128 v[12:15], v3 offset:0
    ds_read_b32 v16, v3 offset:68
    s_addk_i32 m0, 0x1000
    s_waitcnt vmcnt(21)
    buffer_load_dwordx4 v24, s[32:35], s57 offen offset:0 nt lds
    s_waitcnt vmcnt(21)
    buffer_load_dwordx4 v25, s[32:35], s57 offen offset:1024 nt lds
    v_subrev_u32 v9, 8, v8
    ds_write_b32 v4, v9 offset:4864
    s_waitcnt lgkmcnt(1)
    v_readfirstlane_b32 s56, v16
    v_min3_i32 v12, v12, v13, v14
    v_min_i32 v12, v12, v15
    v_cmp_gt_i32 vcc, s46, v12
    s_waitcnt vmcnt(21)
    buffer_load_dwordx4 v26, s[32:35], s57 offen offset:2048 nt lds
    s_waitcnt vmcnt(21)
    buffer_load_dwordx4 v27, s[32:35], s57 offen offset:3072 nt lds
    v_add_u32 v8, 16, v8
    s_and_b32 s51, s51, 31
    s_cbranch_scc0 L_phase
    s_cbranch_vccnz L_stall
    s_cmp_le_i32 s56, -2
    s_cbranch_scc1 L_body0
    s_cmp_le_i32 s56, -1
    s_cbranch_scc1 L_body1
    s_cmp_le_i32 s56, 0
    s_cbranch_scc1 L_body2
    s_cmp_le_i32 s56, 1
    s_cbranch_scc1 L_body3
    s_cmp_le_i32 s56, 2
    s_cbranch_scc1 L_body4
    s_cmp_le_i32 s56, 5
    s_cbranch_scc1 L_body5
    s_branch L_body6
L_body5:
    s_mov_b32 m0, s52
    s_mov_b32 s54, s58
    s_waitcnt vmcnt(23)
    buffer_load_dwordx4 v20, s[32:35], s54 offen offset:0 nt lds
    s_xor_b32 s57, s54, 17408
    s_add_u32 s51, s51, 1
    s_waitcnt vmcnt(23)
    buffer_load_dwordx4 v21, s[32:35], s54 offen offset:1024 nt lds
    s_bitcmp1_b32 s51, 0
    s_cselect_b32 s55, 132096, 0
    s_xor_b32 s58, s50, s55
    s_waitcnt vmcnt(23)
    buffer_load_dwordx4 v22, s[32:35], s54 offen offset:2048 nt lds
    s_bitcmp1_b32 s51, 1
    s_cselect_b32 s55, 264192, 0
    s_xor_b32 s58, s58, s55
    s_waitcnt vmcnt(23)
    buffer_load_dwordx4 v23, s[32:35], s54 offen offset:3072 nt lds
    v_subrev_u32 v9, 20, v8
    ds_write_b32 v4, v9 offset:4864
    s_bitcmp1_b32 s51, 2
    s_cselect_b32 s55, 541696, 0
    s_xor_b32 s58, s58, s55
    s_addk_i32 m0, 0x1000
    s_waitcnt vmcnt(23)
    buffer_load_dwordx4 v24, s[32:35], s54 offen offset:0 nt lds
    s_bitcmp1_b32 s51, 3
    s_cselect_b32 s55, 1048576, 0
    s_xor_b32 s58, s58, s55
    s_waitcnt vmcnt(23)
    buffer_load_dwordx4 v25, s[32:35], s54 offen offset:1024 nt lds
    s_bitcmp1_b32 s51, 4
    s_cselect_b32 s55, 2097152, 0
    s_xor_b32 s58, s58, s55
    s_waitcnt vmcnt(23)
    buffer_load_dwordx4 v26, s[32:35], s54 offen offset:2048 nt lds
    s_add_u32 s52, s52, 16384
    s_and_b32 s52, s52, 131071
    s_waitcnt vmcnt(23)
    buffer_load_dwordx4 v27, s[32:35], s54 offen offset:3072 nt lds
    v_subrev_u32 v9, 16, v8
    ds_write_b32 v4, v9 offset:4864
    s_addk_i32 m0, 0x1000
    s_waitcnt vmcnt(23)
    buffer_load_dwordx4 v20, s[32:35], s57 offen offset:0 nt lds
    s_add_i32 s53, s53, 1
    s_sub_i32 s46, s53, 4
    s_waitcnt vmcnt(23)
    buffer_load_dwordx4 v21, s[32:35], s57 offen offset:1024 nt lds
    s_max_i32 s46, s46, 1
    s_min_i32 s46, s46, s53
    s_waitcnt vmcnt(23)
    buffer_load_dwordx4 v22, s[32:35], s57 offen offset:2048 nt lds
    s_waitcnt vmcnt(23)
    buffer_load_dwordx4 v23, s[32:35], s57 offen offset:3072 nt lds
    v_subrev_u32 v9, 12, v8
    ds_write_b32 v4, v9 offset:4864
    ds_read_b128 v[12:15], v3 offset:0
    ds_read_b32 v16, v3 offset:68
    s_addk_i32 m0, 0x1000
    s_waitcnt vmcnt(23)
    buffer_load_dwordx4 v24, s[32:35], s57 offen offset:0 nt lds
    s_waitcnt vmcnt(23)
    buffer_load_dwordx4 v25, s[32:35], s57 offen offset:1024 nt lds
    s_waitcnt lgkmcnt(0)
    v_readfirstlane_b32 s56, v16
    v_min3_i32 v12, v12, v13, v14
    v_min_i32 v12, v12, v15
    v_cmp_gt_i32 vcc, s46, v12
    s_waitcnt vmcnt(23)
    buffer_load_dwordx4 v26, s[32:35], s57 offen offset:2048 nt lds
    s_waitcnt vmcnt(23)
    buffer_load_dwordx4 v27, s[32:35], s57 offen offset:3072 nt lds
    v_subrev_u32 v9, 8, v8
    ds_write_b32 v4, v9 offset:4864
    v_add_u32 v8, 16, v8
    s_and_b32 s51, s51, 31
    s_cbranch_scc0 L_phase
    s_cbranch_vccnz L_stall
    s_cmp_le_i32 s56, -2
    s_cbranch_scc1 L_body0
    s_cmp_le_i32 s56, -1
    s_cbranch_scc1 L_body1
    s_cmp_le_i32 s56, 0
    s_cbranch_scc1 L_body2
    s_cmp_le_i32 s56, 1
    s_cbranch_scc1 L_body3
    s_cmp_le_i32 s56, 2
    s_cbranch_scc1 L_body4
    s_cmp_le_i32 s56, 5
    s_cbranch_scc1 L_body5
    s_branch L_body6
L_body6:
    s_mov_b32 m0, s52
    s_mov_b32 s54, s58
    s_waitcnt vmcnt(30)
    buffer_load_dwordx4 v20, s[32:35], s54 offen offset:0 nt lds
    s_xor_b32 s57, s54, 17408
    s_add_u32 s51, s51, 1
    s_waitcnt vmcnt(30)
    buffer_load_dwordx4 v21, s[32:35], s54 offen offset:1024 nt lds
    s_bitcmp1_b32 s51, 0
    s_cselect_b32 s55, 132096, 0
    s_xor_b32 s58, s50, s55
    s_waitcnt vmcnt(30)
    buffer_load_dwordx4 v22, s[32:35], s54 offen offset:2048 nt lds
    v_subrev_u32 v9, 28, v8
    ds_write_b32 v4, v9 offset:4864
    s_bitcmp1_b32 s51, 1
    s_cselect_b32 s55, 264192, 0
    s_xor_b32 s58, s58, s55
    s_waitcnt vmcnt(30)
    buffer_load_dwordx4 v23, s[32:35], s54 offen offset:3072 nt lds
    s_bitcmp1_b32 s51, 2
    s_cselect_b32 s55, 541696, 0
    s_xor_b32 s58, s58, s55
    s_addk_i32 m0, 0x1000
    s_waitcnt vmcnt(30)
    buffer_load_dwordx4 v24, s[32:35], s54 offen offset:0 nt lds
    s_bitcmp1_b32 s51, 3
    s_cselect_b32 s55, 1048576, 0
    s_xor_b32 s58, s58, s55
    s_waitcnt vmcnt(30)
    buffer_load_dwordx4 v25, s[32:35], s54 offen offset:1024 nt lds
    s_bitcmp1_b32 s51, 4
    s_cselect_b32 s55, 2097152, 0
    s_xor_b32 s58, s58, s55
    s_waitcnt vmcnt(30)
    buffer_load_dwordx4 v26, s[32:35], s54 offen offset:2048 nt lds
    v_subrev_u32 v9, 24, v8
    ds_write_b32 v4, v9 offset:4864
    s_add_u32 s52, s52, 16384
    s_and_b32 s52, s52, 131071
    s_waitcnt vmcnt(30)
    buffer_load_dwordx4 v27, s[32:35], s54 offen offset:3072 nt lds
    s_addk_i32 m0, 0x1000
    s_waitcnt vmcnt(30)
    buffer_load_dwordx4 v20, s[32:35], s57 offen offset:0 nt lds
    s_add_i32 s53, s53, 1
    s_sub_i32 s46, s53, 4
    s_waitcnt vmcnt(30)
    buffer_load_dwordx4 v21, s[32:35], s57 offen offset:1024 nt lds
    s_max_i32 s46, s46, 1
    s_min_i32 s46, s46, s53
    s_waitcnt vmcnt(30)
    buffer_load_dwordx4 v22, s[32:35], s57 offen offset:2048 nt lds
    v_subrev_u32 v9, 20, v8
    ds_write_b32 v4, v9 offset:4864
    s_waitcnt vmcnt(30)
    buffer_load_dwordx4 v23, s[32:35], s57 offen offset:3072 nt lds
    ds_read_b128 v[12:15], v3 offset:0
    ds_read_b32 v16, v3 offset:68
    s_addk_i32 m0, 0x1000
    s_waitcnt vmcnt(30)
    buffer_load_dwordx4 v24, s[32:35], s57 offen offset:0 nt lds
    s_waitcnt vmcnt(30)
    buffer_load_dwordx4 v25, s[32:35], s57 offen offset:1024 nt lds
    s_waitcnt lgkmcnt(0)
    v_readfirstlane_b32 s56, v16
    v_min3_i32 v12, v12, v13, v14
    v_min_i32 v12, v12, v15
    v_cmp_gt_i32 vcc, s46, v12
    s_waitcnt vmcnt(30)
    buffer_load_dwordx4 v26, s[32:35], s57 offen offset:2048 nt lds
    v_subrev_u32 v9, 16, v8
    ds_write_b32 v4, v9 offset:4864
    s_waitcnt vmcnt(30)
    buffer_load_dwordx4 v27, s[32:35], s57 offen offset:3072 nt lds
    v_add_u32 v8, 16, v8
    s_and_b32 s51, s51, 31
    s_cbranch_scc0 L_phase
    s_cbranch_vccnz L_stall
    s_cmp_le_i32 s56, -2
    s_cbranch_scc1 L_body0
    s_cmp_le_i32 s56, -1
    s_cbranch_scc1 L_body1
    s_cmp_le_i32 s56, 0
    s_cbranch_scc1 L_body2
    s_cmp_le_i32 s56, 1
    s_cbranch_scc1 L_body3
    s_cmp_le_i32 s56, 2
    s_cbranch_scc1 L_body4
    s_cmp_le_i32 s56, 5
    s_cbranch_scc1 L_body5
    s_branch L_body6
L_phase:
    s_cmp_eq_i32 s53, 126
    s_cbranch_scc0 L_switch
    v_subrev_u32 v9, 20, v8
    s_waitcnt vmcnt(20)
    ds_write_b32 v4, v9 offset:4864
    v_subrev_u32 v9, 16, v8
    s_waitcnt vmcnt(16)
    ds_write_b32 v4, v9 offset:4864
    v_subrev_u32 v9, 12, v8
    s_waitcnt vmcnt(12)
    ds_write_b32 v4, v9 offset:4864
    v_subrev_u32 v9, 8, v8
    s_waitcnt vmcnt(8)
    ds_write_b32 v4, v9 offset:4864
    v_subrev_u32 v9, 4, v8
    s_waitcnt vmcnt(4)
    ds_write_b32 v4, v9 offset:4864
    v_subrev_u32 v9, 0, v8
    s_waitcnt vmcnt(0)
    ds_write_b32 v4, v9 offset:4864
    s_endpgm
L_switch:
    s_mov_b64 s[32:33], s[8:9]
    s_mov_b64 s[8:9], s[16:17]
    s_mov_b64 s[16:17], s[18:19]
    s_cbranch_vccz L_disp
L_stall:
    s_sub_u32 s44, s44, 1
    s_cbranch_scc1 L_exit
    ds_read_b128 v[12:15], v3 offset:0
    ds_read_b32 v16, v3 offset:68
    s_waitcnt lgkmcnt(0)
    v_readfirstlane_b32 s56, v16
    v_min3_i32 v12, v12, v13, v14
    v_min_i32 v12, v12, v15
    v_cmp_gt_i32 vcc, s46, v12
    s_cbranch_vccnz L_stall
L_disp:
    s_cmp_le_i32 s56, -2
    s_cbranch_scc1 L_body0
    s_cmp_le_i32 s56, -1
    s_cbranch_scc1 L_body1
    s_cmp_le_i32 s56, 0
    s_cbranch_scc1 L_body2
    s_cmp_le_i32 s56, 1
    s_cbranch_scc1 L_body3
    s_cmp_le_i32 s56, 2
    s_cbranch_scc1 L_body4
    s_cmp_le_i32 s56, 5
    s_cbranch_scc1 L_body5
    s_branch L_body6
L_helper:
    s_mov_b32 s44, 0x1000000
    s_mov_b32 s35, 0x20000
    v_mov_b32 v3, 147456
    s_lshl_b32 s28, s40, 4
    s_add_u32 s28, s28, s41
    s_movk_i32 s62, 0xff
    s_sub_u32 s57, s2, 64
    s_min_u32 s57, s57, s2
    s_and_b32 s45, s57, 7
    s_lshl_b32 s45, s45, 2
    s_bfe_u32 s46, s57, 131075
    s_add_u32 s45, s45, s46
    s_andn2_b32 s57, s57, 31
    s_add_u32 s57, s57, s45
    s_cmp_ge_u32 s41, 8
    s_cselect_b32 s57, 0xff, s57
    s_bfe_u32 s46, s41, 131073
    s_mul_i32 s46, s46, 288
    v_bfe_u32 v94, v0, 3, 1
    v_mul_u32_u24 v94, 1152, v94
    v_add_u32 v94, s46, v94
    v_mul_u32_u24 v95, 72, v2
    v_add_u32 v94, v94, v95
    v_mov_b32 v96, 1048448
    s_waitcnt lgkmcnt(0)
    s_mov_b64 exec, 1
    global_load_dword v29, v96, s[30:31] sc1
    s_mov_b64 exec, -1
    global_load_dwordx4 v[8:11], v94, s[4:5] offset:0
    global_load_dwordx4 v[12:15], v94, s[4:5] offset:16
    global_load_dwordx4 v[16:19], v94, s[4:5] offset:32
    global_load_dwordx4 v[20:23], v94, s[4:5] offset:48
    global_load_dwordx2 v[24:25], v94, s[4:5] offset:64
    s_barrier
    s_cmp_lt_u32 s41, 8
    s_cbranch_scc1 L_nogl
    s_mov_b64 s[32:33], s[4:5]
    s_mov_b32 s34, 1152
    s_mov_b64 s[36:37], s[24:25]
    s_mov_b32 s38, 1152
    v_lshlrev_b32 v94, 3, v0
    buffer_load_dwordx2 v[76:77], v94, s[32:35], 0 offen offset:0
    buffer_load_dwordx2 v[82:83], v94, s[36:39], 0 offen offset:0
    buffer_load_dwordx2 v[78:79], v94, s[32:35], 0 offen offset:512
    buffer_load_dwordx2 v[84:85], v94, s[36:39], 0 offen offset:512
    buffer_load_dwordx2 v[80:81], v94, s[32:35], 0 offen offset:1024
    buffer_load_dwordx2 v[86:87], v94, s[36:39], 0 offen offset:1024
    s_add_u32 s32, s4, 1152
    s_addc_u32 s33, s5, 0
    buffer_load_dwordx2 v[176:177], v94, s[32:35], 0 offen offset:0
    buffer_load_dwordx2 v[178:179], v94, s[32:35], 0 offen offset:512
    buffer_load_dwordx2 v[180:181], v94, s[32:35], 0 offen offset:1024
L_nogl:
    v_and_b32 v94, 1, v0
    v_lshlrev_b32 v94, 4, v94
    v_mov_b32 v95, 0xffff
    v_lshlrev_b32 v94, v94, v95
    v_bfe_u32 v95, v0, 1, 2
    v_cmp_eq_u32 vcc, 0, v95
    s_nop 1
    v_cndmask_b32 v4, 0, v94, vcc
    v_cmp_eq_u32 vcc, 1, v95
    s_nop 1
    v_cndmask_b32 v5, 0, v94, vcc
    v_cmp_eq_u32 vcc, 2, v95
    s_nop 1
    v_cndmask_b32 v6, 0, v94, vcc
    v_cmp_eq_u32 vcc, 3, v95
    s_nop 1
    v_cndmask_b32 v7, 0, v94, vcc
    v_lshlrev_b32 v30, 4, v0
    v_add_u32 v30, 49152, v30
    s_mov_b32 s55, 1069066811
    s_mov_b32 s50, 0
    s_mov_b32 s47, 0x01000100
    s_mov_b32 s48, 0x03020302
    s_mov_b32 s42, 1
    s_mul_i32 s46, s40, 4864
    s_add_u32 s46, s46, 524288
    v_lshl_add_u32 v31, v1, 3, s46
    s_getreg_b32 s46, hwreg(20, 0, 4)
    s_waitcnt vmcnt(0)
    v_readfirstlane_b32 s29, v29
    s_add_u32 s45, s29, 1
    s_and_b32 s45, s45, 15
    v_mov_b32 v100, s45
    s_add_u32 s45, s29, 2
    v_mov_b32 v95, s45
    s_add_u32 s29, s29, 4
    s_and_b32 s45, s29, s62
    v_mov_b32 v102, s45
    v_mov_b32 v32, s29
    v_mov_b32 v33, s46
    s_lshl_b64 exec, 1, s41
    global_store_dwordx2 v31, v[32:33], s[30:31] sc1
    s_mov_b64 exec, 1
    ds_write_b32 v3, v95 offset:60
    s_mov_b64 exec, -1
    v_perm_b32 v94, v8, v8, s47
    v_and_b32 v104, v94, v4
    v_and_b32 v105, v94, v5
    v_and_b32 v106, v94, v6
    v_and_b32 v107, v94, v7
    v_perm_b32 v94, v8, v8, s48
    v_and_b32 v108, v94, v4
    v_and_b32 v109, v94, v5
    v_and_b32 v110, v94, v6
    v_and_b32 v111, v94, v7
    v_perm_b32 v94, v9, v9, s47
    v_and_b32 v112, v94, v4
    v_and_b32 v113, v94, v5
    v_and_b32 v114, v94, v6
    v_and_b32 v115, v94, v7
    v_perm_b32 v94, v9, v9, s48
    v_and_b32 v116, v94, v4
    v_and_b32 v117, v94, v5
    v_and_b32 v118, v94, v6
    v_and_b32 v119, v94, v7
    v_perm_b32 v94, v10, v10, s47
    v_and_b32 v120, v94, v4
    v_and_b32 v121, v94, v5
    v_and_b32 v122, v94, v6
    v_and_b32 v123, v94, v7
    v_perm_b32 v94, v10, v10, s48
    v_and_b32 v124, v94, v4
    v_and_b32 v125, v94, v5
    v_and_b32 v126, v94, v6
    v_and_b32 v127, v94, v7
    v_perm_b32 v94, v11, v11, s47
    v_and_b32 v128, v94, v4
    v_and_b32 v129, v94, v5
    v_and_b32 v130, v94, v6
    v_and_b32 v131, v94, v7
    v_perm_b32 v94, v11, v11, s48
    v_and_b32 v132, v94, v4
    v_and_b32 v133, v94, v5
    v_and_b32 v134, v94, v6
    v_and_b32 v135, v94, v7
    v_perm_b32 v94, v12, v12, s47
    v_and_b32 v136, v94, v4
    v_and_b32 v137, v94, v5
    v_and_b32 v138, v94, v6
    v_and_b32 v139, v94, v7
    v_perm_b32 v94, v12, v12, s48
    v_and_b32 v140, v94, v4
    v_and_b32 v141, v94, v5
    v_and_b32 v142, v94, v6
    v_and_b32 v143, v94, v7
    v_perm_b32 v94, v13, v13, s47
    v_and_b32 v144, v94, v4
    v_and_b32 v145, v94, v5
    v_and_b32 v146, v94, v6
    v_and_b32 v147, v94, v7
    v_perm_b32 v94, v13, v13, s48
    v_and_b32 v148, v94, v4
    v_and_b32 v149, v94, v5
    v_and_b32 v150, v94, v6
    v_and_b32 v151, v94, v7
    v_perm_b32 v94, v14, v14, s47
    v_and_b32 v152, v94, v4
    v_and_b32 v153, v94, v5
    v_and_b32 v154, v94, v6
    v_and_b32 v155, v94, v7
    v_perm_b32 v94, v14, v14, s48
    v_and_b32 v156, v94, v4
    v_and_b32 v157, v94, v5
    v_and_b32 v158, v94, v6
    v_and_b32 v159, v94, v7
    v_perm_b32 v94, v15, v15, s47
    v_and_b32 v160, v94, v4
    v_and_b32 v161, v94, v5
    v_and_b32 v162, v94, v6
    v_and_b32 v163, v94, v7
    v_perm_b32 v94, v15, v15, s48
    v_and_b32 v164, v94, v4
    v_and_b32 v165, v94, v5
    v_and_b32 v166, v94, v6
    v_and_b32 v167, v94, v7
    v_perm_b32 v94, v16, v16, s47
    v_and_b32 v168, v94, v4
    v_and_b32 v169, v94, v5
    v_and_b32 v170, v94, v6
    v_and_b32 v171, v94, v7
    v_perm_b32 v94, v16, v16, s48
    v_and_b32 v172, v94, v4
    v_and_b32 v173, v94, v5
    v_and_b32 v174, v94, v6
    v_and_b32 v175, v94, v7
    s_cmp_ge_i32 s50, 9
    s_cbranch_scc1 L_ok2
L_p1:
    s_sub_u32 s44, s44, 1
    s_cbranch_scc1 L_exit
    ds_read_b32 v95, v3 offset:4864
    s_waitcnt lgkmcnt(0)
    v_cmp_gt_i32 vcc, 9, v95
    v_readfirstlane_b32 s50, v95
    s_cbranch_vccnz L_p1
L_ok2:
    ds_read_b128 v[36:39], v30 offset:0
    ds_read_b128 v[40:43], v30 offset:1024
    ds_read_b128 v[44:47], v30 offset:2048
    ds_read_b128 v[48:51], v30 offset:3072
    ds_read_b128 v[52:55], v30 offset:4096
    ds_read_b128 v[56:59], v30 offset:5120
    ds_read_b128 v[60:63], v30 offset:6144
    ds_read_b128 v[64:67], v30 offset:7168
    ds_read_b128 v[68:71], v30 offset:8192
    s_waitcnt lgkmcnt(8)
    v_mfma_f32_16x16x32_bf16 v[88:91], v[104:107], v[36:39], 0
    s_waitcnt lgkmcnt(7)
    v_mfma_f32_16x16x32_bf16 v[88:91], v[108:111], v[40:43], v[88:91]
    s_waitcnt lgkmcnt(6)
    v_mfma_f32_16x16x32_bf16 v[88:91], v[112:115], v[44:47], v[88:91]
    s_waitcnt lgkmcnt(5)
    v_mfma_f32_16x16x32_bf16 v[88:91], v[116:119], v[48:51], v[88:91]
    s_waitcnt lgkmcnt(4)
    v_mfma_f32_16x16x32_bf16 v[88:91], v[120:123], v[52:55], v[88:91]
    s_waitcnt lgkmcnt(3)
    v_mfma_f32_16x16x32_bf16 v[88:91], v[124:127], v[56:59], v[88:91]
    s_waitcnt lgkmcnt(2)
    v_mfma_f32_16x16x32_bf16 v[88:91], v[128:131], v[60:63], v[88:91]
    s_waitcnt lgkmcnt(1)
    v_mfma_f32_16x16x32_bf16 v[88:91], v[132:135], v[64:67], v[88:91]
    s_waitcnt lgkmcnt(0)
    v_mfma_f32_16x16x32_bf16 v[88:91], v[136:139], v[68:71], v[88:91]
    s_cmp_ge_i32 s50, 18
    s_cbranch_scc1 L_ok4
L_p3:
    s_sub_u32 s44, s44, 1
    s_cbranch_scc1 L_exit
    ds_read_b32 v95, v3 offset:4864
    s_waitcnt lgkmcnt(0)
    v_cmp_gt_i32 vcc, 18, v95
    v_readfirstlane_b32 s50, v95
    s_cbranch_vccnz L_p3
L_ok4:
    ds_read_b128 v[36:39], v30 offset:9216
    ds_read_b128 v[40:43], v30 offset:10240
    ds_read_b128 v[44:47], v30 offset:11264
    ds_read_b128 v[48:51], v30 offset:12288
    ds_read_b128 v[52:55], v30 offset:13312
    ds_read_b128 v[56:59], v30 offset:14336
    ds_read_b128 v[60:63], v30 offset:15360
    ds_read_b128 v[64:67], v30 offset:16384
    ds_read_b128 v[68:71], v30 offset:17408
    s_waitcnt lgkmcnt(8)
    v_mfma_f32_16x16x32_bf16 v[88:91], v[140:143], v[36:39], v[88:91]
    s_waitcnt lgkmcnt(7)
    v_mfma_f32_16x16x32_bf16 v[88:91], v[144:147], v[40:43], v[88:91]
    s_waitcnt lgkmcnt(6)
    v_mfma_f32_16x16x32_bf16 v[88:91], v[148:151], v[44:47], v[88:91]
    s_waitcnt lgkmcnt(5)
    v_mfma_f32_16x16x32_bf16 v[88:91], v[152:155], v[48:51], v[88:91]
    s_waitcnt lgkmcnt(4)
    v_mfma_f32_16x16x32_bf16 v[88:91], v[156:159], v[52:55], v[88:91]
    s_waitcnt lgkmcnt(3)
    v_mfma_f32_16x16x32_bf16 v[88:91], v[160:163], v[56:59], v[88:91]
    s_waitcnt lgkmcnt(2)
    v_mfma_f32_16x16x32_bf16 v[88:91], v[164:167], v[60:63], v[88:91]
    s_waitcnt lgkmcnt(1)
    v_mfma_f32_16x16x32_bf16 v[88:91], v[168:171], v[64:67], v[88:91]
    s_waitcnt lgkmcnt(0)
    v_mfma_f32_16x16x32_bf16 v[88:91], v[172:175], v[68:71], v[88:91]
    v_perm_b32 v94, v17, v17, s47
    v_and_b32 v104, v94, v4
    v_and_b32 v105, v94, v5
    v_and_b32 v106, v94, v6
    v_and_b32 v107, v94, v7
    v_perm_b32 v94, v17, v17, s48
    v_and_b32 v108, v94, v4
    v_and_b32 v109, v94, v5
    v_and_b32 v110, v94, v6
    v_and_b32 v111, v94, v7
    v_perm_b32 v94, v18, v18, s47
    v_and_b32 v112, v94, v4
    v_and_b32 v113, v94, v5
    v_and_b32 v114, v94, v6
    v_and_b32 v115, v94, v7
    v_perm_b32 v94, v18, v18, s48
    v_and_b32 v116, v94, v4
    v_and_b32 v117, v94, v5
    v_and_b32 v118, v94, v6
    v_and_b32 v119, v94, v7
    v_perm_b32 v94, v19, v19, s47
    v_and_b32 v120, v94, v4
    v_and_b32 v121, v94, v5
    v_and_b32 v122, v94, v6
    v_and_b32 v123, v94, v7
    v_perm_b32 v94, v19, v19, s48
    v_and_b32 v124, v94, v4
    v_and_b32 v125, v94, v5
    v_and_b32 v126, v94, v6
    v_and_b32 v127, v94, v7
    v_perm_b32 v94, v20, v20, s47
    v_and_b32 v128, v94, v4
    v_and_b32 v129, v94, v5
    v_and_b32 v130, v94, v6
    v_and_b32 v131, v94, v7
    v_perm_b32 v94, v20, v20, s48
    v_and_b32 v132, v94, v4
    v_and_b32 v133, v94, v5
    v_and_b32 v134, v94, v6
    v_and_b32 v135, v94, v7
    v_perm_b32 v94, v21, v21, s47
    v_and_b32 v136, v94, v4
    v_and_b32 v137, v94, v5
    v_and_b32 v138, v94, v6
    v_and_b32 v139, v94, v7
    v_perm_b32 v94, v21, v21, s48
    v_and_b32 v140, v94, v4
    v_and_b32 v141, v94, v5
    v_and_b32 v142, v94, v6
    v_and_b32 v143, v94, v7
    v_perm_b32 v94, v22, v22, s47
    v_and_b32 v144, v94, v4
    v_and_b32 v145, v94, v5
    v_and_b32 v146, v94, v6
    v_and_b32 v147, v94, v7
    v_perm_b32 v94, v22, v22, s48
    v_and_b32 v148, v94, v4
    v_and_b32 v149, v94, v5
    v_and_b32 v150, v94, v6
    v_and_b32 v151, v94, v7
    v_perm_b32 v94, v23, v23, s47
    v_and_b32 v152, v94, v4
    v_and_b32 v153, v94, v5
    v_and_b32 v154, v94, v6
    v_and_b32 v155, v94, v7
    v_perm_b32 v94, v23, v23, s48
    v_and_b32 v156, v94, v4
    v_and_b32 v157, v94, v5
    v_and_b32 v158, v94, v6
    v_and_b32 v159, v94, v7
    v_perm_b32 v94, v24, v24, s47
    v_and_b32 v160, v94, v4
    v_and_b32 v161, v94, v5
    v_and_b32 v162, v94, v6
    v_and_b32 v163, v94, v7
    v_perm_b32 v94, v24, v24, s48
    v_and_b32 v164, v94, v4
    v_and_b32 v165, v94, v5
    v_and_b32 v166, v94, v6
    v_and_b32 v167, v94, v7
    v_perm_b32 v94, v25, v25, s47
    v_and_b32 v168, v94, v4
    v_and_b32 v169, v94, v5
    v_and_b32 v170, v94, v6
    v_and_b32 v171, v94, v7
    v_perm_b32 v94, v25, v25, s48
    v_and_b32 v172, v94, v4
    v_and_b32 v173, v94, v5
    v_and_b32 v174, v94, v6
    v_and_b32 v175, v94, v7
    s_cmp_ge_i32 s50, 27
    s_cbranch_scc1 L_ok6
L_p5:
    s_sub_u32 s44, s44, 1
    s_cbranch_scc1 L_exit
    ds_read_b32 v95, v3 offset:4864
    s_waitcnt lgkmcnt(0)
    v_cmp_gt_i32 vcc, 27, v95
    v_readfirstlane_b32 s50, v95
    s_cbranch_vccnz L_p5
L_ok6:
    ds_read_b128 v[36:39], v30 offset:18432
    ds_read_b128 v[40:43], v30 offset:19456
    ds_read_b128 v[44:47], v30 offset:20480
    ds_read_b128 v[48:51], v30 offset:21504
    ds_read_b128 v[52:55], v30 offset:22528
    ds_read_b128 v[56:59], v30 offset:23552
    ds_read_b128 v[60:63], v30 offset:24576
    ds_read_b128 v[64:67], v30 offset:25600
    ds_read_b128 v[68:71], v30 offset:26624
    s_waitcnt lgkmcnt(8)
    v_mfma_f32_16x16x32_bf16 v[88:91], v[104:107], v[36:39], v[88:91]
    s_waitcnt lgkmcnt(7)
    v_mfma_f32_16x16x32_bf16 v[88:91], v[108:111], v[40:43], v[88:91]
    s_waitcnt lgkmcnt(6)
    v_mfma_f32_16x16x32_bf16 v[88:91], v[112:115], v[44:47], v[88:91]
    s_waitcnt lgkmcnt(5)
    v_mfma_f32_16x16x32_bf16 v[88:91], v[116:119], v[48:51], v[88:91]
    s_waitcnt lgkmcnt(4)
    v_mfma_f32_16x16x32_bf16 v[88:91], v[120:123], v[52:55], v[88:91]
    s_waitcnt lgkmcnt(3)
    v_mfma_f32_16x16x32_bf16 v[88:91], v[124:127], v[56:59], v[88:91]
    s_waitcnt lgkmcnt(2)
    v_mfma_f32_16x16x32_bf16 v[88:91], v[128:131], v[60:63], v[88:91]
    s_waitcnt lgkmcnt(1)
    v_mfma_f32_16x16x32_bf16 v[88:91], v[132:135], v[64:67], v[88:91]
    s_waitcnt lgkmcnt(0)
    v_mfma_f32_16x16x32_bf16 v[88:91], v[136:139], v[68:71], v[88:91]
    s_cmp_ge_i32 s50, 36
    s_cbranch_scc1 L_ok8
L_p7:
    s_sub_u32 s44, s44, 1
    s_cbranch_scc1 L_exit
    ds_read_b32 v95, v3 offset:4864
    s_waitcnt lgkmcnt(0)
    v_cmp_gt_i32 vcc, 36, v95
    v_readfirstlane_b32 s50, v95
    s_cbranch_vccnz L_p7
L_ok8:
    ds_read_b128 v[36:39], v30 offset:27648
    ds_read_b128 v[40:43], v30 offset:28672
    ds_read_b128 v[44:47], v30 offset:29696
    ds_read_b128 v[48:51], v30 offset:30720
    ds_read_b128 v[52:55], v30 offset:31744
    ds_read_b128 v[56:59], v30 offset:32768
    ds_read_b128 v[60:63], v30 offset:33792
    ds_read_b128 v[64:67], v30 offset:34816
    ds_read_b128 v[68:71], v30 offset:35840
    s_waitcnt lgkmcnt(8)
    v_mfma_f32_16x16x32_bf16 v[88:91], v[140:143], v[36:39], v[88:91]
    s_waitcnt lgkmcnt(7)
    v_mfma_f32_16x16x32_bf16 v[88:91], v[144:147], v[40:43], v[88:91]
    s_waitcnt lgkmcnt(6)
    v_mfma_f32_16x16x32_bf16 v[88:91], v[148:151], v[44:47], v[88:91]
    s_waitcnt lgkmcnt(5)
    v_mfma_f32_16x16x32_bf16 v[88:91], v[152:155], v[48:51], v[88:91]
    s_waitcnt lgkmcnt(4)
    v_mfma_f32_16x16x32_bf16 v[88:91], v[156:159], v[52:55], v[88:91]
    s_waitcnt lgkmcnt(3)
    v_mfma_f32_16x16x32_bf16 v[88:91], v[160:163], v[56:59], v[88:91]
    s_waitcnt lgkmcnt(2)
    v_mfma_f32_16x16x32_bf16 v[88:91], v[164:167], v[60:63], v[88:91]
    s_waitcnt lgkmcnt(1)
    v_mfma_f32_16x16x32_bf16 v[88:91], v[168:171], v[64:67], v[88:91]
    s_waitcnt lgkmcnt(0)
    v_mfma_f32_16x16x32_bf16 v[88:91], v[172:175], v[68:71], v[88:91]
    v_mov_b32 v95, 1
    s_mov_b64 exec, 1
    ds_write_b32 v3, v95 offset:64
    s_mov_b64 exec, -1
    s_waitcnt vmcnt(0)
L_idpoll:
    s_sub_u32 s44, s44, 1
    s_cbranch_scc1 L_exit
    global_load_dwordx2 v[94:95], v31, s[30:31] sc1
    s_waitcnt vmcnt(0)
    v_cmp_ne_u32 vcc, s29, v94
    s_cbranch_vccnz L_idpoll
    v_cmp_ne_u32 vcc, v33, v95
    s_cbranch_vccz L_near
    s_mov_b32 s42, 0
L_near:
    s_lshl_b32 s47, s28, 10
    v_lshl_add_u32 v95, v0, 4, s47
    v_bfi_b32 v88, 15, v100, v88
    v_bfi_b32 v89, 15, v100, v89
    v_bfi_b32 v90, 15, v100, v90
    v_bfi_b32 v91, 15, v100, v91
    s_cmp_eq_u32 s42, 0
    s_cbranch_scc1 L_far9
    global_store_dwordx4 v95, v[88:91], s[30:31]
    s_branch L_pub10
L_far9:
    global_store_dwordx4 v95, v[88:91], s[30:31] sc1
L_pub10:
    v_mov_b32 v94, s42
    s_mov_b64 exec, 1
    ds_write_b32 v3, v94 offset:72
    s_mov_b64 exec, -1
    s_lshl_b32 s47, s40, 14
    s_lshr_b32 s48, s41, 3
    s_lshl_b32 s48, s48, 9
    s_add_u32 s47, s47, s48
    s_add_u32 s47, s47, 4096
    v_and_b32 v96, 31, v0
    v_lshl_add_u32 v96, v96, 4, s47
    v_lshrrev_b32 v97, 5, v0
    v_lshl_add_u32 v96, v97, 10, v96
    v_lshl_add_u32 v97, v97, 8, v3
    v_lshl_add_u32 v97, v1, 4, v97
    v_and_b32 v95, 1, v2
    v_lshl_add_u32 v97, v95, 3, v97
    v_add_u32 v13, 0x2000, v96
    s_waitcnt vmcnt(0)
    s_cmp_ge_i32 s50, 72
    s_cbranch_scc1 L_ok12
L_p11:
    s_sub_u32 s44, s44, 1
    s_cbranch_scc1 L_exit
    ds_read_b32 v95, v3 offset:4864
    s_waitcnt lgkmcnt(0)
    v_cmp_gt_i32 vcc, 72, v95
    v_readfirstlane_b32 s50, v95
    s_cbranch_vccnz L_p11
L_ok12:
L_qg:
    s_sub_u32 s44, s44, 1
    s_cbranch_scc1 L_exit
    global_load_dwordx4 v[36:39], v96, s[30:31] offset:-4096 sc1
    global_load_dwordx4 v[40:43], v96, s[30:31] offset:-2048 sc1
    global_load_dwordx4 v[44:47], v96, s[30:31] offset:0 sc1
    global_load_dwordx4 v[48:51], v96, s[30:31] offset:2048 sc1
    global_load_dwordx4 v[52:55], v13, s[30:31] offset:-4096 sc1
    global_load_dwordx4 v[56:59], v13, s[30:31] offset:-2048 sc1
    global_load_dwordx4 v[60:63], v13, s[30:31] offset:0 sc1
    global_load_dwordx4 v[64:67], v13, s[30:31] offset:2048 sc1
    s_waitcnt vmcnt(0)
    v_xor_b32 v36, v100, v36
    v_xor_b32 v37, v100, v37
    v_xor_b32 v38, v100, v38
    v_xor_b32 v39, v100, v39
    v_xor_b32 v40, v100, v40
    v_xor_b32 v41, v100, v41
    v_xor_b32 v42, v100, v42
    v_xor_b32 v43, v100, v43
    v_xor_b32 v44, v100, v44
    v_xor_b32 v45, v100, v45
    v_xor_b32 v46, v100, v46
    v_xor_b32 v47, v100, v47
    v_xor_b32 v48, v100, v48
    v_xor_b32 v49, v100, v49
    v_xor_b32 v50, v100, v50
    v_xor_b32 v51, v100, v51
    v_xor_b32 v52, v100, v52
    v_xor_b32 v53, v100, v53
    v_xor_b32 v54, v100, v54
    v_xor_b32 v55, v100, v55
    v_xor_b32 v56, v100, v56
    v_xor_b32 v57, v100, v57
    v_xor_b32 v58, v100, v58
    v_xor_b32 v59, v100, v59
    v_xor_b32 v60, v100, v60
    v_xor_b32 v61, v100, v61
    v_xor_b32 v62, v100, v62
    v_xor_b32 v63, v100, v63
    v_xor_b32 v64, v100, v64
    v_xor_b32 v65, v100, v65
    v_xor_b32 v66, v100, v66
    v_xor_b32 v67, v100, v67
    v_or3_b32 v95, v36, v37, v38
    v_or3_b32 v95, v95, v39, v40
    v_or3_b32 v95, v95, v41, v42
    v_or3_b32 v95, v95, v43, v44
    v_or3_b32 v95, v95, v45, v46
    v_or3_b32 v95, v95, v47, v48
    v_or3_b32 v95, v95, v49, v50
    v_or3_b32 v95, v95, v51, v52
    v_or3_b32 v95, v95, v53, v54
    v_or3_b32 v95, v95, v55, v56
    v_or3_b32 v95, v95, v57, v58
    v_or3_b32 v95, v95, v59, v60
    v_or3_b32 v95, v95, v61, v62
    v_or3_b32 v95, v95, v63, v64
    v_or3_b32 v95, v95, v65, v66
    v_or_b32 v95, v95, v67
    v_and_b32 v95, 15, v95
    v_cmp_ne_u32 vcc, 0, v95
    s_cbranch_vccnz L_qg
    v_add_f32 v36, v36, v40
    v_add_f32 v37, v37, v41
    v_add_f32 v38, v38, v42
    v_add_f32 v39, v39, v43
    v_add_f32 v44, v44, v48
    v_add_f32 v45, v45, v49
    v_add_f32 v46, v46, v50
    v_add_f32 v47, v47, v51
    v_add_f32 v36, v36, v44
    v_add_f32 v37, v37, v45
    v_add_f32 v38, v38, v46
    v_add_f32 v39, v39, v47
    v_cvt_pk_bf16_f32 v36, v36, v37
    v_cvt_pk_bf16_f32 v37, v38, v39
    ds_write_b64 v97, v[36:37] offset:3328
    v_add_f32 v52, v52, v56
    v_add_f32 v53, v53, v57
    v_add_f32 v54, v54, v58
    v_add_f32 v55, v55, v59
    v_add_f32 v60, v60, v64
    v_add_f32 v61, v61, v65
    v_add_f32 v62, v62, v66
    v_add_f32 v63, v63, v67
    v_add_f32 v52, v52, v60
    v_add_f32 v53, v53, v61
    v_add_f32 v54, v54, v62
    v_add_f32 v55, v55, v63
    v_cvt_pk_bf16_f32 v52, v52, v53
    v_cvt_pk_bf16_f32 v53, v54, v55
    ds_write_b64 v97, v[52:53] offset:3840
    v_mov_b32 v95, 2
    s_mov_b64 exec, 1
    ds_write_b32 v3, v95 offset:52
    s_mov_b64 exec, -1
    s_cmp_lt_u32 s41, 8
    s_cbranch_scc1 L_nogate
    v_mov_b32 v40, 0
    v_mov_b32 v41, 0
    v_lshlrev_b32 v53, 16, v82
    v_and_b32 v55, 0xffff0000, v82
    v_lshlrev_b32 v52, 16, v76
    v_and_b32 v54, 0xffff0000, v76
    v_mul_f32 v52, v52, v53
    v_mul_f32 v54, v54, v55
    v_cvt_pk_bf16_f32 v52, 0, v52
    v_cvt_pk_bf16_f32 v54, 0, v54
    v_add_f32 v40, v40, v52
    v_add_f32 v40, v40, v54
    v_lshlrev_b32 v52, 16, v176
    v_and_b32 v54, 0xffff0000, v176
    v_mul_f32 v52, v52, v53
    v_mul_f32 v54, v54, v55
    v_cvt_pk_bf16_f32 v52, 0, v52
    v_cvt_pk_bf16_f32 v54, 0, v54
    v_add_f32 v41, v41, v52
    v_add_f32 v41, v41, v54
    v_lshlrev_b32 v53, 16, v83
    v_and_b32 v55, 0xffff0000, v83
    v_lshlrev_b32 v52, 16, v77
    v_and_b32 v54, 0xffff0000, v77
    v_mul_f32 v52, v52, v53
    v_mul_f32 v54, v54, v55
    v_cvt_pk_bf16_f32 v52, 0, v52
    v_cvt_pk_bf16_f32 v54, 0, v54
    v_add_f32 v40, v40, v52
    v_add_f32 v40, v40, v54
    v_lshlrev_b32 v52, 16, v177
    v_and_b32 v54, 0xffff0000, v177
    v_mul_f32 v52, v52, v53
    v_mul_f32 v54, v54, v55
    v_cvt_pk_bf16_f32 v52, 0, v52
    v_cvt_pk_bf16_f32 v54, 0, v54
    v_add_f32 v41, v41, v52
    v_add_f32 v41, v41, v54
    v_lshlrev_b32 v53, 16, v84
    v_and_b32 v55, 0xffff0000, v84
    v_lshlrev_b32 v52, 16, v78
    v_and_b32 v54, 0xffff0000, v78
    v_mul_f32 v52, v52, v53
    v_mul_f32 v54, v54, v55
    v_cvt_pk_bf16_f32 v52, 0, v52
    v_cvt_pk_bf16_f32 v54, 0, v54
    v_add_f32 v40, v40, v52
    v_add_f32 v40, v40, v54
    v_lshlrev_b32 v52, 16, v178
    v_and_b32 v54, 0xffff0000, v178
    v_mul_f32 v52, v52, v53
    v_mul_f32 v54, v54, v55
    v_cvt_pk_bf16_f32 v52, 0, v52
    v_cvt_pk_bf16_f32 v54, 0, v54
    v_add_f32 v41, v41, v52
    v_add_f32 v41, v41, v54
    v_lshlrev_b32 v53, 16, v85
    v_and_b32 v55, 0xffff0000, v85
    v_lshlrev_b32 v52, 16, v79
    v_and_b32 v54, 0xffff0000, v79
    v_mul_f32 v52, v52, v53
    v_mul_f32 v54, v54, v55
    v_cvt_pk_bf16_f32 v52, 0, v52
    v_cvt_pk_bf16_f32 v54, 0, v54
    v_add_f32 v40, v40, v52
    v_add_f32 v40, v40, v54
    v_lshlrev_b32 v52, 16, v179
    v_and_b32 v54, 0xffff0000, v179
    v_mul_f32 v52, v52, v53
    v_mul_f32 v54, v54, v55
    v_cvt_pk_bf16_f32 v52, 0, v52
    v_cvt_pk_bf16_f32 v54, 0, v54
    v_add_f32 v41, v41, v52
    v_add_f32 v41, v41, v54
    v_lshlrev_b32 v53, 16, v86
    v_and_b32 v55, 0xffff0000, v86
    v_lshlrev_b32 v52, 16, v80
    v_and_b32 v54, 0xffff0000, v80
    v_mul_f32 v52, v52, v53
    v_mul_f32 v54, v54, v55
    v_cvt_pk_bf16_f32 v52, 0, v52
    v_cvt_pk_bf16_f32 v54, 0, v54
    v_add_f32 v40, v40, v52
    v_add_f32 v40, v40, v54
    v_lshlrev_b32 v52, 16, v180
    v_and_b32 v54, 0xffff0000, v180
    v_mul_f32 v52, v52, v53
    v_mul_f32 v54, v54, v55
    v_cvt_pk_bf16_f32 v52, 0, v52
    v_cvt_pk_bf16_f32 v54, 0, v54
    v_add_f32 v41, v41, v52
    v_add_f32 v41, v41, v54
    v_lshlrev_b32 v53, 16, v87
    v_and_b32 v55, 0xffff0000, v87
    v_lshlrev_b32 v52, 16, v81
    v_and_b32 v54, 0xffff0000, v81
    v_mul_f32 v52, v52, v53
    v_mul_f32 v54, v54, v55
    v_cvt_pk_bf16_f32 v52, 0, v52
    v_cvt_pk_bf16_f32 v54, 0, v54
    v_add_f32 v40, v40, v52
    v_add_f32 v40, v40, v54
    v_lshlrev_b32 v52, 16, v181
    v_and_b32 v54, 0xffff0000, v181
    v_mul_f32 v52, v52, v53
    v_mul_f32 v54, v54, v55
    v_cvt_pk_bf16_f32 v52, 0, v52
    v_cvt_pk_bf16_f32 v54, 0, v54
    v_add_f32 v41, v41, v52
    v_add_f32 v41, v41, v54
    s_nop 1
    v_permlane32_swap_b32 v40, v41
    v_add_f32 v40, v40, v41
    s_nop 1
    v_add_f32_dpp v40, v40, v40 row_ror:1 row_mask:0xf bank_mask:0xf
    s_nop 1
    v_add_f32_dpp v40, v40, v40 row_ror:2 row_mask:0xf bank_mask:0xf
    s_nop 1
    v_add_f32_dpp v40, v40, v40 row_ror:4 row_mask:0xf bank_mask:0xf
    s_nop 1
    v_add_f32_dpp v40, v40, v40 row_ror:8 row_mask:0xf bank_mask:0xf
    v_mov_b32 v94, v40
    s_nop 1
    v_permlane16_swap_b32 v94, v40
    v_add_f32 v40, v94, v40
    v_cvt_pk_bf16_f32 v40, 0, v40
    v_mul_f32 v40, s55, v40
    v_exp_f32 v40, -v40
    s_nop 0
    v_add_f32 v40, 1.0, v40
    v_rcp_f32 v40, v40
    v_lshrrev_b32 v94, 5, v0
    v_cvt_pk_bf16_f32 v40, 0, v40
    v_sub_f32 v41, 1.0, v40
    v_cvt_pk_bf16_f32 v41, 0, v41
    v_lshl_add_u32 v94, v94, 3, v3
    s_mov_b32 exec_lo, 1
    s_mov_b32 exec_hi, 1
    ds_write_b64 v94, v[40:41] offset:208
    s_mov_b64 exec, -1
L_nogate:
    s_lshr_b32 s47, s28, 3
    s_lshl_b32 s47, s47, 8
    s_add_u32 s47, s47, 1064960
    v_and_b32 v94, 31, v0
    v_lshlrev_b32 v94, 4, v94
    v_xor_b32 v15, s47, v94
    s_and_b32 s48, s28, 7
    s_lshl_b32 s48, s48, 4
    s_add_u32 s47, s47, s48
    v_lshrrev_b32 v94, 5, v0
    v_lshl_add_u32 v14, v94, 7, s47
    v_lshl_add_u32 v8, v94, 5, v3
    v_and_b32 v94, 8, v0
    v_add_u32 v9, v94, v3
    s_mov_b32 s56, 1
    s_movk_i32 s51, 840
L_hnext:
    s_cmp_eq_u32 s42, 0
    s_cbranch_scc1 L_hbranch
    v_readfirstlane_b32 s45, v14
    s_add_u32 s98, s30, s45
    s_addc_u32 s99, s31, 0
    s_load_dword s97, s[98:99], 0
    s_load_dword s97, s[98:99], 128
L_hbranch:
    s_sub_u32 s44, s44, 1
    s_cbranch_scc1 L_exit
    ds_read_b128 v[60:63], v3 offset:32
    ds_read_b128 v[52:55], v8 offset:128
    ds_read_b128 v[56:59], v8 offset:144
    s_waitcnt lgkmcnt(0)
    v_min3_i32 v60, v60, v61, v62
    v_min_i32 v60, v60, v63
    v_cmp_gt_i32 vcc, s56, v60
    s_cbranch_vccnz L_hbranch
    v_max3_f32 v64, v52, v54, v56
    v_max_f32 v64, v64, v58
    v_sub_f32 v60, v52, v64
    v_sub_f32 v61, v54, v64
    v_sub_f32 v62, v56, v64
    v_sub_f32 v63, v58, v64
    v_mul_f32 v60, s55, v60
    v_mul_f32 v61, s55, v61
    v_mul_f32 v62, s55, v62
    v_mul_f32 v63, s55, v63
    v_exp_f32 v60, v60
    v_exp_f32 v61, v61
    v_exp_f32 v62, v62
    v_exp_f32 v63, v63
    v_mov_b32 v66, s29
    v_mov_b32 v67, s29
    v_mul_f32 v65, v60, v53
    v_fmac_f32 v65, v61, v55
    v_fmac_f32 v65, v62, v57
    v_fmac_f32 v65, v63, v59
    s_mov_b32 exec_lo, 1
    s_mov_b32 exec_hi, 1
    s_cmp_eq_u32 s42, 0
    s_cbranch_scc1 L_far13
    global_store_dwordx4 v14, v[64:67], s[30:31]
    s_branch L_pub14
L_far13:
    global_store_dwordx4 v14, v[64:67], s[30:31] sc1
L_pub14:
    s_mov_b64 exec, -1
    s_cmp_ge_i32 s50, s51
    s_cbranch_scc1 L_ok16
L_p15:
    s_sub_u32 s44, s44, 1
    s_cbranch_scc1 L_exit
    ds_read_b32 v95, v3 offset:4864
    s_waitcnt lgkmcnt(0)
    v_cmp_gt_i32 vcc, s51, v95
    v_readfirstlane_b32 s50, v95
    s_cbranch_vccnz L_p15
L_ok16:
L_mlpoll:
    s_sub_u32 s44, s44, 1
    s_cbranch_scc1 L_exit
    global_load_dwordx4 v[36:39], v15, s[30:31] sc1
    s_waitcnt vmcnt(0)
    v_xor_b32 v38, s29, v38
    v_xor_b32 v39, s29, v39
    v_or_b32 v38, v38, v39
    v_cmp_ne_u32 vcc, 0, v38
    s_cbranch_vccnz L_mlpoll
    v_mov_b32 v40, v36
    s_nop 1
    v_max_f32_dpp v40, v40, v40 quad_perm:[1,0,3,2] row_mask:0xf bank_mask:0xf
    s_nop 1
    v_max_f32_dpp v40, v40, v40 quad_perm:[2,3,0,1] row_mask:0xf bank_mask:0xf
    s_nop 1
    v_max_f32_dpp v40, v40, v40 row_half_mirror row_mask:0xf bank_mask:0xf
    v_sub_f32 v36, v36, v40
    v_mul_f32 v36, s55, v36
    v_exp_f32 v36, v36
    v_mov_b32 v95, s56
    v_mul_f32 v41, v36, v37
    s_nop 1
    v_add_f32_dpp v41, v41, v41 quad_perm:[1,0,3,2] row_mask:0xf bank_mask:0xf
    s_nop 1
    v_add_f32_dpp v41, v41, v41 quad_perm:[2,3,0,1] row_mask:0xf bank_mask:0xf
    s_nop 1
    v_add_f32_dpp v41, v41, v41 row_half_mirror row_mask:0xf bank_mask:0xf
    v_rcp_f32 v41, v41
    s_mov_b64 exec, 0x101
    ds_write_b64 v9, v[40:41] offset:192
    s_mov_b64 exec, 1
    ds_write_b32 v3, v95 offset:56
    s_mov_b64 exec, -1
    v_add_u32 v14, 0x2000, v14
    v_add_u32 v15, 0x2000, v15
    s_add_u32 s51, s51, 1024
    s_add_u32 s56, s56, 1
    s_cmp_eq_u32 s56, 2
    s_cbranch_scc1 L_hnext
    s_cmp_ge_u32 s57, 72
    s_cbranch_scc1 L_rdone
    s_mul_i32 s47, s57, 4096
    s_add_u32 s47, s47, 1116160
    v_lshl_add_u32 v34, v1, 2, s47
    v_and_b32 v94, 1, v2
    v_mul_u32_u24 v94, 128, v94
    v_add_u32 v34, v34, v94
    v_lshrrev_b32 v94, 5, v0
    v_mul_u32_u24 v94, 256, v94
    v_add_u32 v34, v34, v94
    s_lshl_b32 s47, s57, 5
    v_lshl_add_u32 v35, v1, 1, s47
    v_mov_b32 v96, 1048448
    v_mov_b32 v97, s29
L_p17:
    s_sub_u32 s44, s44, 1
    s_cbranch_scc1 L_exit
    ds_read_b32 v95, v3 offset:28
    s_waitcnt lgkmcnt(0)
    v_cmp_gt_i32 vcc, 2, v95
    s_cbranch_vccnz L_p17
L_rpoll:
    s_sub_u32 s44, s44, 1
    s_cbranch_scc1 L_exit
    global_load_dword v40, v34, s[30:31] offset:-2048 sc1
    global_load_dword v41, v34, s[30:31] offset:-1536 sc1
    global_load_dword v42, v34, s[30:31] offset:-1024 sc1
    global_load_dword v43, v34, s[30:31] offset:-512 sc1
    global_load_dword v44, v34, s[30:31] offset:0 sc1
    global_load_dword v45, v34, s[30:31] offset:512 sc1
    global_load_dword v46, v34, s[30:31] offset:1024 sc1
    global_load_dword v47, v34, s[30:31] offset:1536 sc1
    s_waitcnt vmcnt(0)
    v_xor_b32 v40, v102, v40
    v_xor_b32 v41, v102, v41
    v_xor_b32 v42, v102, v42
    v_xor_b32 v43, v102, v43
    v_xor_b32 v44, v102, v44
    v_xor_b32 v45, v102, v45
    v_xor_b32 v46, v102, v46
    v_xor_b32 v47, v102, v47
    v_or3_b32 v94, v40, v41, v42
    v_or3_b32 v94, v94, v43, v44
    v_or3_b32 v94, v94, v45, v46
    v_or_b32 v94, v94, v47
    v_and_b32 v94, s62, v94
    v_cmp_ne_u32 vcc, 0, v94
    v_pk_add_f32 v[40:41], v[40:41], v[44:45]
    v_pk_add_f32 v[42:43], v[42:43], v[46:47]
    v_pk_add_f32 v[40:41], v[40:41], v[42:43]
    v_add_f32 v40, v40, v41
    s_cbranch_vccnz L_rpoll
    v_mov_b32 v95, v40
    s_nop 1
    v_permlane32_swap_b32 v95, v40
    v_add_f32 v40, v95, v40
    v_mov_b32 v95, v40
    s_nop 1
    v_permlane16_swap_b32 v95, v40
    v_add_f32 v40, v95, v40
    v_cvt_pk_bf16_f32 v40, 0, v40
    s_mov_b64 exec, 0xffff
    global_store_short_d16_hi v35, v40, s[26:27]
    s_cmp_eq_u32 s2, 0
    s_cbranch_scc0 L_rdone
    s_mov_b64 exec, 1
    global_store_dword v96, v97, s[30:31]
L_rdone:
    s_endpgm
L_roles:
    s_mov_b32 s44, 0x1000000
    s_mov_b32 s35, 0x20000
    v_mov_b32 v3, 147456
    s_lshl_b32 s28, s40, 4
    s_add_u32 s28, s28, s41
    s_movk_i32 s62, 0xff
    s_cmp_eq_u32 s3, 6
    s_cbranch_scc1 L_control
    s_setprio 2
    s_sub_u32 s43, s3, 2
    s_lshl_b32 s47, s43, 2
    v_add_u32 v19, s47, v3
    v_and_b32 v94, 1, v0
    v_lshlrev_b32 v94, 4, v94
    v_mov_b32 v95, 0xffff
    v_lshlrev_b32 v94, v94, v95
    v_bfe_u32 v95, v0, 1, 2
    v_cmp_eq_u32 vcc, 0, v95
    s_nop 1
    v_cndmask_b32 v4, 0, v94, vcc
    v_cmp_eq_u32 vcc, 1, v95
    s_nop 1
    v_cndmask_b32 v5, 0, v94, vcc
    v_cmp_eq_u32 vcc, 2, v95
    s_nop 1
    v_cndmask_b32 v6, 0, v94, vcc
    v_cmp_eq_u32 vcc, 3, v95
    s_nop 1
    v_cndmask_b32 v7, 0, v94, vcc
    s_lshl_b32 s47, s43, 12
    v_and_b32 v94, 3, v0
    v_lshl_add_u32 v94, v94, 10, s47
    v_lshrrev_b32 v95, 2, v1
    v_lshl_add_u32 v94, v95, 8, v94
    v_and_b32 v96, 1, v95
    v_mul_u32_u24 v96, 3, v96
    v_lshrrev_b32 v97, 1, v95
    v_xor_b32 v96, v96, v97
    v_and_b32 v95, 3, v0
    v_lshl_add_u32 v95, v96, 2, v95
    v_xor_b32 v95, v95, v2
    v_lshl_add_u32 v8, v95, 4, v94
    v_xor_b32 v9, 64, v8
    v_xor_b32 v10, 128, v8
    v_xor_b32 v11, 192, v8
    v_and_b32 v96, 1, v2
    v_mul_u32_u24 v96, 3, v96
    v_lshrrev_b32 v97, 1, v2
    v_xor_b32 v96, v96, v97
    v_lshlrev_b32 v96, 2, v96
    v_xor_b32 v96, v96, v0
    v_lshl_add_u32 v12, v96, 4, s47
    s_add_u32 s47, s47, 131072
    v_lshrrev_b32 v94, 3, v0
    v_lshl_add_u32 v98, v94, 4, s47
    s_cmp_eq_u32 s43, 3
    s_cselect_b32 s47, 0, s43
    s_lshl_b32 s47, s47, 10
    s_add_u32 s47, s47, 147712
    v_lshl_add_u32 v101, v0, 4, s47
    v_bfe_u32 v95, v0, 3, 1
    v_lshl_add_u32 v18, v95, 8, v3
    v_lshl_add_u32 v18, v2, 4, v18
    s_lshl_b32 s47, s40, 14
    s_and_b32 s48, s41, 7
    s_lshl_b32 s48, s48, 11
    s_add_u32 s47, s47, s48
    s_lshr_b32 s48, s41, 3
    s_lshl_b32 s48, s48, 9
    s_add_u32 s47, s47, s48
    v_and_b32 v94, 7, v0
    v_lshl_add_u32 v103, v94, 4, s47
    v_lshl_add_u32 v103, v2, 7, v103
    v_lshl_add_u32 v103, v95, 10, v103
    s_lshl_b32 s47, s40, 14
    s_and_b32 s46, s41, 1
    s_lshl_b32 s48, s46, 10
    s_add_u32 s47, s47, s48
    s_lshl_b32 s48, s43, 7
    s_add_u32 s47, s47, s48
    v_lshl_add_u32 v152, v94, 4, s47
    v_lshrrev_b32 v96, 3, v0
    v_lshl_add_u32 v152, v96, 11, v152
    s_lshl_b32 s47, s43, 6
    s_add_u32 s47, s47, 151808
    v_lshl_add_u32 v153, v94, 3, s47
    v_and_b32 v94, 1, v2
    v_lshl_add_u32 v153, v94, 2, v153
    v_lshrrev_b32 v95, 5, v0
    v_lshl_add_u32 v153, v95, 8, v153
    v_bfe_u32 v95, v0, 2, 1
    v_lshl_add_u32 v156, v95, 8, v3
    v_lshl_add_u32 v156, v2, 4, v156
    s_mul_i32 s45, s40, 256
    s_mul_i32 s46, s46, 128
    s_add_u32 s45, s45, s46
    s_bfe_u32 s46, s41, 131073
    s_mul_i32 s46, s46, 3
    s_add_u32 s46, s46, s43
    s_mul_i32 s46, s46, 12288
    s_add_u32 s46, s46, s45
    s_add_u32 s46, s46, 1114112
    v_lshl_add_u32 v154, v1, 2, s46
    v_mul_u32_u24 v94, 147456, v94
    v_add_u32 v154, v154, v94
    v_add_u32 v155, 4096, v154
    v_add_u32 v157, 8192, v154
    s_lshl_b32 s46, s40, 3
    s_and_b32 s48, s41, 7
    s_add_u32 s46, s46, s48
    s_lshl_b32 s46, s46, 7
    s_add_u32 s46, s46, 1900544
    s_lshl_b32 s47, s40, 14
    s_and_b32 s48, s41, 7
    s_lshl_b32 s48, s48, 11
    s_add_u32 s47, s47, s48
    s_lshr_b32 s48, s41, 3
    s_lshl_b32 s48, s48, 9
    s_add_u32 s47, s47, s48
    s_or_b32 s47, s47, 0x200
    v_and_b32 v94, 31, v0
    s_mul_i32 s45, s43, 3
    s_add_u32 s45, s45, 0
    s_and_b32 s48, s45, 4
    s_add_u32 s48, s48, s45
    s_lshl_b32 s48, s48, 7
    s_add_u32 s48, s48, s47
    s_cmp_ge_u32 s45, 8
    s_cselect_b32 s48, s46, s48
    v_lshl_add_u32 v176, v94, 2, s48
    s_mul_i32 s45, s43, 3
    s_add_u32 s45, s45, 1
    s_and_b32 s48, s45, 4
    s_add_u32 s48, s48, s45
    s_lshl_b32 s48, s48, 7
    s_add_u32 s48, s48, s47
    s_cmp_ge_u32 s45, 8
    s_cselect_b32 s48, s46, s48
    v_lshl_add_u32 v177, v94, 2, s48
    s_mul_i32 s45, s43, 3
    s_add_u32 s45, s45, 2
    s_and_b32 s48, s45, 4
    s_add_u32 s48, s48, s45
    s_lshl_b32 s48, s48, 7
    s_add_u32 s48, s48, s47
    s_cmp_ge_u32 s45, 8
    s_cselect_b32 s48, s46, s48
    v_lshl_add_u32 v178, v94, 2, s48
    v_bfe_u32 v96, v0, 2, 2
    v_lshl_add_u32 v96, v96, 2, v2
    v_mul_u32_u24 v96, 576, v96
    v_and_b32 v95, 3, v0
    v_lshl_add_u32 v96, v95, 3, v96
    s_mul_i32 s47, s43, 96
    s_add_u32 s47, s47, 86016
    v_add_u32 v96, s47, v96
    s_mov_b32 s54, 1035273459
    s_mov_b32 s55, 1069066811
    s_mov_b32 s58, 0x01010101
    s_mov_b32 s59, 0x01010101
    s_mov_b32 s50, 0
    s_lshl_b32 s51, s43, 2
    s_add_u32 s51, s51, 76
    s_mov_b32 s52, 0
    s_mov_b32 s53, 2
    s_mov_b32 s56, 1
    s_mov_b32 s63, 1
    s_cmp_eq_u32 s43, 3
    s_cbranch_scc1 L_wqwait
L_p19:
    s_sub_u32 s44, s44, 1
    s_cbranch_scc1 L_exit
    ds_read_b32 v95, v3 offset:4864
    s_waitcnt lgkmcnt(0)
    v_cmp_gt_i32 vcc, 72, v95
    s_cbranch_vccnz L_p19
    ds_read_b64_tr_b16 v[104:105], v96 offset:0
    ds_read_b64_tr_b16 v[106:107], v96 offset:288
    ds_read_b64_tr_b16 v[120:121], v96 offset:32
    ds_read_b64_tr_b16 v[122:123], v96 offset:320
    ds_read_b64_tr_b16 v[136:137], v96 offset:64
    ds_read_b64_tr_b16 v[138:139], v96 offset:352
    ds_read_b64_tr_b16 v[108:109], v96 offset:9216
    ds_read_b64_tr_b16 v[110:111], v96 offset:9504
    ds_read_b64_tr_b16 v[124:125], v96 offset:9248
    ds_read_b64_tr_b16 v[126:127], v96 offset:9536
    ds_read_b64_tr_b16 v[140:141], v96 offset:9280
    ds_read_b64_tr_b16 v[142:143], v96 offset:9568
    ds_read_b64_tr_b16 v[112:113], v96 offset:18432
    ds_read_b64_tr_b16 v[114:115], v96 offset:18720
    ds_read_b64_tr_b16 v[128:129], v96 offset:18464
    ds_read_b64_tr_b16 v[130:131], v96 offset:18752
    ds_read_b64_tr_b16 v[144:145], v96 offset:18496
    ds_read_b64_tr_b16 v[146:147], v96 offset:18784
    ds_read_b64_tr_b16 v[116:117], v96 offset:27648
    ds_read_b64_tr_b16 v[118:119], v96 offset:27936
    ds_read_b64_tr_b16 v[132:133], v96 offset:27680
    ds_read_b64_tr_b16 v[134:135], v96 offset:27968
    ds_read_b64_tr_b16 v[148:149], v96 offset:27712
    ds_read_b64_tr_b16 v[150:151], v96 offset:28000
    s_branch L_stgfree
L_wqwait:
    s_waitcnt lgkmcnt(0)
    s_lshl_b32 s45, s28, 10
    s_add_u32 s98, s30, s45
    s_addc_u32 s99, s31, 0
    s_load_dword s97, s[98:99], 0
    s_load_dword s97, s[98:99], 64
    s_load_dword s97, s[98:99], 128
    s_load_dword s97, s[98:99], 192
    s_load_dword s97, s[98:99], 256
    s_load_dword s97, s[98:99], 320
    s_load_dword s97, s[98:99], 384
    s_load_dword s97, s[98:99], 448
    s_load_dword s97, s[98:99], 512
    s_load_dword s97, s[98:99], 576
    s_load_dword s97, s[98:99], 640
    s_load_dword s97, s[98:99], 704
    s_load_dword s97, s[98:99], 768
    s_load_dword s97, s[98:99], 832
    s_load_dword s97, s[98:99], 896
    s_load_dword s97, s[98:99], 960
    s_cmp_ge_u32 s41, 8
    s_cbranch_scc1 L_noextra
    s_lshl_b32 s45, s40, 3
    s_and_b32 s48, s41, 7
    s_add_u32 s45, s45, s48
    s_lshl_b32 s45, s45, 7
    s_add_u32 s45, s45, 1900544
    s_add_u32 s98, s30, s45
    s_addc_u32 s99, s31, 0
    s_load_dword s97, s[98:99], 0
    s_load_dword s97, s[98:99], 64
L_noextra:
L_p21:
    s_sub_u32 s44, s44, 1
    s_cbranch_scc1 L_exit
    ds_read_b32 v95, v3 offset:64
    s_waitcnt lgkmcnt(0)
    v_cmp_gt_i32 vcc, 1, v95
    s_cbranch_vccnz L_p21
L_stgfree:
    v_mov_b32 v94, 1
    s_mov_b64 exec, 1
    ds_write_b32 v19, v94 offset:0
    s_mov_b64 exec, -1
L_branch:
L_p23:
    s_sub_u32 s44, s44, 1
    s_cbranch_scc1 L_exit
    ds_read_b32 v95, v3 offset:52
    s_waitcnt lgkmcnt(0)
    v_cmp_gt_i32 vcc, s56, v95
    s_cbranch_vccnz L_p23
    ds_read_b32 v102, v3 offset:60
    ds_read_b32 v96, v3 offset:72
    ds_read_b128 v[20:23], v18 offset:3328
    ds_read_b128 v[24:27], v18 offset:3392
    ds_read_b128 v[28:31], v18 offset:3456
    ds_read_b128 v[32:35], v18 offset:3520
    v_add_u32 v18, 0x200, v18
    v_mov_b32 v17, v98
    s_add_u32 s57, s53, 32
    s_waitcnt lgkmcnt(0)
    v_readfirstlane_b32 s42, v96
    v_and_b32 v102, s62, v102
L_ktile:
    v_add_u32 v13, s52, v8
    v_add_u32 v14, s52, v9
    v_add_u32 v15, s52, v10
    v_add_u32 v16, s52, v11
    s_cmp_ge_i32 s50, s51
    s_cbranch_scc1 L_ok26
L_p25:
    s_sub_u32 s44, s44, 1
    s_cbranch_scc1 L_exit
    ds_read_b32 v95, v3 offset:4864
    s_waitcnt lgkmcnt(0)
    v_cmp_gt_i32 vcc, s51, v95
    v_readfirstlane_b32 s50, v95
    s_cbranch_vccnz L_p25
L_ok26:
    ds_read_b128 v[36:39], v13
    ds_read_b128 v[40:43], v14
    ds_read_b128 v[44:47], v15
    ds_read_b128 v[48:51], v16
    v_mov_b32 v94, s53
    s_mov_b64 exec, 1
    ds_write_b32 v19, v94 offset:0
    s_mov_b64 exec, -1
    s_add_u32 s51, s51, 16
    s_add_u32 s52, s52, 16384
    s_and_b32 s52, s52, 131071
    s_add_u32 s53, s53, 1
    s_cmp_lg_u32 s53, s57
    s_waitcnt lgkmcnt(4)
    v_mfma_f32_16x16x32_bf16 v[68:71], v[36:39], v[20:23], 0
    s_waitcnt lgkmcnt(3)
    v_mfma_f32_16x16x32_bf16 v[68:71], v[40:43], v[24:27], v[68:71]
    s_waitcnt lgkmcnt(2)
    v_mfma_f32_16x16x32_bf16 v[68:71], v[44:47], v[28:31], v[68:71]
    s_waitcnt lgkmcnt(1)
    v_mfma_f32_16x16x32_bf16 v[68:71], v[48:51], v[32:35], v[68:71]
    s_mov_b64 exec, s[58:59]
    s_nop 6
    ds_write_b128 v17, v[68:71]
    s_mov_b64 exec, -1
    v_add_u32 v17, 0x80, v17
    s_cbranch_scc1 L_ktile
    s_cmp_eq_u32 s56, 2
    s_cbranch_scc1 L_gpoll
L_mid:
    v_and_b32 v94, 0x36, v0
    v_and_b32 v95, 1, v0
    v_lshl_add_u32 v94, v95, 3, v94
    v_bfe_u32 v97, v0, 3, 1
    v_add_u32 v94, v97, v94
    s_lshl_b32 s47, s43, 12
    s_add_u32 s47, s47, 131072
    v_lshl_add_u32 v96, v94, 4, s47
    ds_read_b128 v[36:39], v96 offset:0
    ds_read_b128 v[40:43], v96 offset:1024
    ds_read_b128 v[44:47], v96 offset:2048
    ds_read_b128 v[48:51], v96 offset:3072
    s_lshl_b32 s47, s43, 3
    s_add_u32 s47, s47, 147584
    v_lshl_add_u32 v97, v97, 5, s47
    v_mov_b32 v88, 0
    v_mov_b32 v89, 0
    v_mov_b32 v90, 0
    v_mov_b32 v91, 0
    s_waitcnt lgkmcnt(0)
    v_cvt_pk_bf16_f32 v36, 0, v36
    v_cvt_pk_bf16_f32 v37, 0, v37
    v_cvt_pk_bf16_f32 v38, 0, v38
    v_cvt_pk_bf16_f32 v39, 0, v39
    v_cvt_pk_bf16_f32 v40, 0, v40
    v_cvt_pk_bf16_f32 v41, 0, v41
    v_cvt_pk_bf16_f32 v42, 0, v42
    v_cvt_pk_bf16_f32 v43, 0, v43
    v_cvt_pk_bf16_f32 v44, 0, v44
    v_cvt_pk_bf16_f32 v45, 0, v45
    v_cvt_pk_bf16_f32 v46, 0, v46
    v_cvt_pk_bf16_f32 v47, 0, v47
    v_cvt_pk_bf16_f32 v48, 0, v48
    v_cvt_pk_bf16_f32 v49, 0, v49
    v_cvt_pk_bf16_f32 v50, 0, v50
    v_cvt_pk_bf16_f32 v51, 0, v51
    v_mul_f32 v36, s54, v36
    v_mul_f32 v37, s54, v37
    v_mul_f32 v38, s54, v38
    v_mul_f32 v39, s54, v39
    v_mul_f32 v40, s54, v40
    v_mul_f32 v41, s54, v41
    v_mul_f32 v42, s54, v42
    v_mul_f32 v43, s54, v43
    v_mul_f32 v44, s54, v44
    v_mul_f32 v45, s54, v45
    v_mul_f32 v46, s54, v46
    v_mul_f32 v47, s54, v47
    v_mul_f32 v48, s54, v48
    v_mul_f32 v49, s54, v49
    v_mul_f32 v50, s54, v50
    v_mul_f32 v51, s54, v51
    v_cvt_pk_bf16_f32 v36, 0, v36
    v_cvt_pk_bf16_f32 v37, 0, v37
    v_cvt_pk_bf16_f32 v38, 0, v38
    v_cvt_pk_bf16_f32 v39, 0, v39
    v_cvt_pk_bf16_f32 v40, 0, v40
    v_cvt_pk_bf16_f32 v41, 0, v41
    v_cvt_pk_bf16_f32 v42, 0, v42
    v_cvt_pk_bf16_f32 v43, 0, v43
    v_cvt_pk_bf16_f32 v44, 0, v44
    v_cvt_pk_bf16_f32 v45, 0, v45
    v_cvt_pk_bf16_f32 v46, 0, v46
    v_cvt_pk_bf16_f32 v47, 0, v47
    v_cvt_pk_bf16_f32 v48, 0, v48
    v_cvt_pk_bf16_f32 v49, 0, v49
    v_cvt_pk_bf16_f32 v50, 0, v50
    v_cvt_pk_bf16_f32 v51, 0, v51
    v_max3_f32 v92, v36, v37, v38
    v_max3_f32 v92, v92, v39, v40
    v_max3_f32 v92, v92, v41, v42
    v_max3_f32 v92, v92, v43, v44
    v_max3_f32 v92, v92, v45, v46
    v_max3_f32 v92, v92, v47, v48
    v_max3_f32 v92, v92, v49, v50
    v_max_f32 v92, v92, v51
    v_max_f32 v92, 0xff7fffff, v92
    s_nop 1
    v_max_f32_dpp v92, v92, v92 quad_perm:[1,0,3,2] row_mask:0xf bank_mask:0xf
    s_nop 1
    v_max_f32_dpp v92, v92, v92 quad_perm:[2,3,0,1] row_mask:0xf bank_mask:0xf
    s_nop 1
    v_max_f32_dpp v92, v92, v92 row_half_mirror row_mask:0xf bank_mask:0xf
    v_mov_b32 v94, v92
    s_nop 1
    v_permlane32_swap_b32 v94, v92
    v_max_f32 v92, v94, v92
    v_mov_b32 v94, v92
    s_nop 1
    v_permlane16_swap_b32 v94, v92
    v_max_f32 v92, v94, v92
    v_sub_f32 v36, v36, v92
    v_sub_f32 v37, v37, v92
    v_sub_f32 v38, v38, v92
    v_sub_f32 v39, v39, v92
    v_sub_f32 v40, v40, v92
    v_sub_f32 v41, v41, v92
    v_sub_f32 v42, v42, v92
    v_sub_f32 v43, v43, v92
    v_sub_f32 v44, v44, v92
    v_sub_f32 v45, v45, v92
    v_sub_f32 v46, v46, v92
    v_sub_f32 v47, v47, v92
    v_sub_f32 v48, v48, v92
    v_sub_f32 v49, v49, v92
    v_sub_f32 v50, v50, v92
    v_sub_f32 v51, v51, v92
    v_mul_f32 v36, s55, v36
    v_mul_f32 v37, s55, v37
    v_mul_f32 v38, s55, v38
    v_mul_f32 v39, s55, v39
    v_mul_f32 v40, s55, v40
    v_mul_f32 v41, s55, v41
    v_mul_f32 v42, s55, v42
    v_mul_f32 v43, s55, v43
    v_mul_f32 v44, s55, v44
    v_mul_f32 v45, s55, v45
    v_mul_f32 v46, s55, v46
    v_mul_f32 v47, s55, v47
    v_mul_f32 v48, s55, v48
    v_mul_f32 v49, s55, v49
    v_mul_f32 v50, s55, v50
    v_mul_f32 v51, s55, v51
    v_exp_f32 v36, v36
    v_exp_f32 v37, v37
    v_exp_f32 v38, v38
    v_exp_f32 v39, v39
    v_exp_f32 v40, v40
    v_exp_f32 v41, v41
    v_exp_f32 v42, v42
    v_exp_f32 v43, v43
    v_exp_f32 v44, v44
    v_exp_f32 v45, v45
    v_exp_f32 v46, v46
    v_exp_f32 v47, v47
    v_exp_f32 v48, v48
    v_exp_f32 v49, v49
    v_exp_f32 v50, v50
    v_exp_f32 v51, v51
    v_cvt_pk_bf16_f32 v72, v36, v36
    v_cvt_pk_bf16_f32 v73, v37, v37
    v_cvt_pk_bf16_f32 v74, v38, v38
    v_cvt_pk_bf16_f32 v75, v39, v39
    v_cvt_pk_bf16_f32 v76, v40, v40
    v_cvt_pk_bf16_f32 v77, v41, v41
    v_cvt_pk_bf16_f32 v78, v42, v42
    v_cvt_pk_bf16_f32 v79, v43, v43
    v_cvt_pk_bf16_f32 v80, v44, v44
    v_cvt_pk_bf16_f32 v81, v45, v45
    v_cvt_pk_bf16_f32 v82, v46, v46
    v_cvt_pk_bf16_f32 v83, v47, v47
    v_cvt_pk_bf16_f32 v84, v48, v48
    v_cvt_pk_bf16_f32 v85, v49, v49
    v_cvt_pk_bf16_f32 v86, v50, v50
    v_cvt_pk_bf16_f32 v87, v51, v51
    ds_write_b128 v96, v[72:75] offset:0
    ds_write_b128 v96, v[76:79] offset:1024
    ds_write_b128 v96, v[80:83] offset:2048
    ds_write_b128 v96, v[84:87] offset:3072
    v_add_f32 v36, v36, v37
    v_add_f32 v38, v38, v39
    v_add_f32 v40, v40, v41
    v_add_f32 v42, v42, v43
    v_add_f32 v44, v44, v45
    v_add_f32 v46, v46, v47
    v_add_f32 v48, v48, v49
    v_add_f32 v50, v50, v51
    v_add_f32 v36, v36, v38
    v_add_f32 v40, v40, v42
    v_add_f32 v44, v44, v46
    v_add_f32 v48, v48, v50
    v_add_f32 v36, v36, v40
    v_add_f32 v44, v44, v48
    v_add_f32 v36, v36, v44
    s_nop 1
    v_add_f32_dpp v36, v36, v36 quad_perm:[1,0,3,2] row_mask:0xf bank_mask:0xf
    s_nop 1
    v_add_f32_dpp v36, v36, v36 quad_perm:[2,3,0,1] row_mask:0xf bank_mask:0xf
    s_nop 1
    v_add_f32_dpp v36, v36, v36 row_half_mirror row_mask:0xf bank_mask:0xf
    v_mov_b32 v94, v36
    s_nop 1
    v_permlane32_swap_b32 v94, v36
    v_add_f32 v36, v94, v36
    v_mov_b32 v94, v36
    s_nop 1
    v_permlane16_swap_b32 v94, v36
    v_add_f32 v36, v94, v36
    v_mov_b32 v93, v36
    v_mov_b32 v94, s56
    s_mov_b64 exec, 0x101
    ds_write_b64 v97, v[92:93]
    s_mov_b64 exec, 1
    ds_write_b32 v19, v94 offset:32
    s_mov_b64 exec, -1
    v_mov_b32 v17, v98
    s_add_u32 s57, s53, 20
L_vtile:
    ds_read_b128 v[68:71], v17
    v_add_u32 v13, s52, v12
    v_xor_b32 v14, 16, v13
    v_xor_b32 v15, 32, v13
    v_xor_b32 v16, 48, v13
    v_add_u32 v17, 0x80, v17
    s_waitcnt lgkmcnt(0)
    v_and_b32 v72, v68, v4
    v_and_b32 v73, v68, v5
    v_and_b32 v74, v68, v6
    v_and_b32 v75, v68, v7
    v_and_b32 v76, v69, v4
    v_and_b32 v77, v69, v5
    v_and_b32 v78, v69, v6
    v_and_b32 v79, v69, v7
    v_and_b32 v80, v70, v4
    v_and_b32 v81, v70, v5
    v_and_b32 v82, v70, v6
    v_and_b32 v83, v70, v7
    v_and_b32 v84, v71, v4
    v_and_b32 v85, v71, v5
    v_and_b32 v86, v71, v6
    v_and_b32 v87, v71, v7
    s_and_b32 s45, s53, 31
    s_cmp_eq_u32 s45, 1
    s_cbranch_scc1 L_vlast
    s_cmp_ge_i32 s50, s51
    s_cbranch_scc1 L_ok28
L_p27:
    s_sub_u32 s44, s44, 1
    s_cbranch_scc1 L_exit
    ds_read_b32 v95, v3 offset:4864
    s_waitcnt lgkmcnt(0)
    v_cmp_gt_i32 vcc, s51, v95
    v_readfirstlane_b32 s50, v95
    s_cbranch_vccnz L_p27
L_ok28:
    ds_read_b128 v[52:55], v13 offset:0
    ds_read_b128 v[56:59], v14 offset:1024
    ds_read_b128 v[60:63], v15 offset:2048
    ds_read_b128 v[64:67], v16 offset:3072
    v_mov_b32 v94, s53
    s_mov_b64 exec, 1
    ds_write_b32 v19, v94 offset:0
    s_mov_b64 exec, -1
    s_add_u32 s51, s51, 16
    s_add_u32 s52, s52, 16384
    s_and_b32 s52, s52, 131071
    s_add_u32 s53, s53, 1
    s_cmp_lg_u32 s53, s57
    s_waitcnt lgkmcnt(4)
    v_mfma_f32_16x16x32_bf16 v[88:91], v[52:55], v[72:75], v[88:91]
    s_waitcnt lgkmcnt(3)
    v_mfma_f32_16x16x32_bf16 v[88:91], v[56:59], v[76:79], v[88:91]
    s_waitcnt lgkmcnt(2)
    v_mfma_f32_16x16x32_bf16 v[88:91], v[60:63], v[80:83], v[88:91]
    s_waitcnt lgkmcnt(1)
    v_mfma_f32_16x16x32_bf16 v[88:91], v[64:67], v[84:87], v[88:91]
    s_cbranch_scc1 L_vtile
    s_and_b32 s45, s53, 31
    s_branch L_factor
L_vlast:
    s_sub_u32 s44, s44, 1
    s_cbranch_scc1 L_exit
    ds_read_b32 v95, v3 offset:4864
    ds_read_b128 v[52:55], v13 offset:0
    ds_read_b128 v[56:59], v14 offset:1024
    ds_read_b128 v[60:63], v15 offset:2048
    ds_read_b128 v[64:67], v16 offset:3072
    s_waitcnt lgkmcnt(4)
    v_cmp_gt_i32 vcc, s51, v95
    s_cbranch_vccnz L_vlast
    s_waitcnt lgkmcnt(3)
    v_mfma_f32_16x16x32_bf16 v[88:91], v[52:55], v[72:75], v[88:91]
    s_waitcnt lgkmcnt(2)
    v_mfma_f32_16x16x32_bf16 v[88:91], v[56:59], v[76:79], v[88:91]
    s_waitcnt lgkmcnt(1)
    v_mfma_f32_16x16x32_bf16 v[88:91], v[60:63], v[80:83], v[88:91]
    s_waitcnt lgkmcnt(0)
    v_mfma_f32_16x16x32_bf16 v[88:91], v[64:67], v[84:87], v[88:91]
    s_cmp_eq_u32 s43, 3
    s_cbranch_scc0 L_part
L_mpoll:
    s_sub_u32 s44, s44, 1
    s_cbranch_scc1 L_exit
    ds_read_b128 v[48:51], v3 offset:16
    ds_read_b128 v[36:39], v101 offset:0
    ds_read_b128 v[40:43], v101 offset:1024
    ds_read_b128 v[44:47], v101 offset:2048
    v_mul_f32 v52, v88, v99
    v_mul_f32 v53, v89, v99
    v_mul_f32 v54, v90, v99
    v_mul_f32 v55, v91, v99
    s_waitcnt lgkmcnt(3)
    v_min3_u32 v48, v48, v49, v50
    v_cmp_gt_u32 vcc, s56, v48
    s_waitcnt lgkmcnt(2)
    v_pk_add_f32 v[52:53], v[52:53], v[36:37]
    v_pk_add_f32 v[54:55], v[54:55], v[38:39]
    s_cbranch_vccnz L_mpoll
    s_waitcnt lgkmcnt(0)
    v_pk_add_f32 v[44:45], v[40:41], v[44:45]
    v_pk_add_f32 v[46:47], v[42:43], v[46:47]
    v_pk_add_f32 v[44:45], v[52:53], v[44:45]
    v_pk_add_f32 v[46:47], v[54:55], v[46:47]
    v_bfi_b32 v44, s62, v102, v44
    v_bfi_b32 v47, s62, v102, v47
    s_cmp_eq_u32 s42, 0
    s_cbranch_scc1 L_far29
    global_store_dwordx4 v103, v[44:47], s[30:31]
    s_branch L_pub30
L_far29:
    global_store_dwordx4 v103, v[44:47], s[30:31] sc1
L_pub30:
    s_branch L_done
L_part:
    s_nop 5
    v_mul_f32 v88, v88, v99
    v_mul_f32 v89, v89, v99
    v_mul_f32 v90, v90, v99
    v_mul_f32 v91, v91, v99
    ds_write_b128 v101, v[88:91]
L_done:
    v_mov_b32 v94, s56
    s_mov_b64 exec, 1
    ds_write_b32 v19, v94 offset:16
    s_mov_b64 exec, -1
    v_mov_b32 v94, s53
    s_mov_b64 exec, 1
    ds_write_b32 v19, v94 offset:0
    s_mov_b64 exec, -1
    s_add_u32 s51, s51, 16
    s_add_u32 s52, s52, 16384
    s_and_b32 s52, s52, 131071
    s_add_u32 s53, s53, 1
    s_cmp_lg_u32 s53, s57
    s_add_u32 s56, s56, 1
    s_cmp_eq_u32 s56, 2
    s_cbranch_scc1 L_branch
    s_cmp_lt_u32 s41, 8
    s_cbranch_scc1 L_cdone
L_gpoll:
    s_sub_u32 s44, s44, 1
    s_cbranch_scc1 L_exit
    global_load_dwordx4 v[36:39], v152, s[30:31] offset:0 sc1
    global_load_dwordx4 v[40:43], v152, s[30:31] offset:512 sc1
    s_waitcnt vmcnt(0)
    v_xor_b32 v36, v102, v36
    v_xor_b32 v39, v102, v39
    v_xor_b32 v40, v102, v40
    v_xor_b32 v43, v102, v43
    v_permlane32_swap_b32 v37, v41
    v_or3_b32 v48, v36, v39, v40
    v_permlane32_swap_b32 v38, v42
    v_or_b32 v48, v48, v43
    v_permlane32_swap_b32 v36, v40
    v_and_b32 v48, s62, v48
    v_permlane32_swap_b32 v39, v43
    v_cmp_ne_u32 vcc, 0, v48
    v_pk_add_f32 v[36:37], v[36:37], v[40:41]
    v_pk_add_f32 v[38:39], v[38:39], v[42:43]
    v_mov_b32 v48, s63
    s_cbranch_vccnz L_gpoll
    v_permlane16_swap_b32 v36, v38
    v_permlane16_swap_b32 v37, v39
    v_pk_add_f32 v[36:37], v[36:37], v[38:39]
    s_nop 1
    v_add_f32_dpp v36, v36, v36 row_ror:8 row_mask:0xf bank_mask:0xf
    v_add_f32_dpp v37, v37, v37 row_ror:8 row_mask:0xf bank_mask:0xf
    v_cvt_pk_bf16_f32 v36, v36, v37
    ds_write_b32 v153, v36
    s_mov_b64 exec, 1
    ds_write_b32 v19, v48 offset:80
    s_mov_b64 exec, -1
    s_cmp_eq_u32 s43, 3
    s_cbranch_scc1 L_gfin
L_gsync:
    s_sub_u32 s44, s44, 1
    s_cbranch_scc1 L_exit
    ds_read_b128 v[52:55], v3 offset:80
    ds_read_b128 v[72:75], v156 offset:4352
    ds_read_b128 v[76:79], v156 offset:4416
    ds_read_b128 v[80:83], v156 offset:4480
    ds_read_b128 v[84:87], v156 offset:4544
    s_waitcnt lgkmcnt(4)
    v_min3_i32 v52, v52, v53, v54
    v_min_i32 v52, v52, v55
    v_cmp_gt_i32 vcc, s63, v52
    s_cbranch_vccnz L_gsync
    s_waitcnt lgkmcnt(3)
    v_mfma_f32_16x16x32_bf16 v[160:163], v[72:75], v[104:107], 0
    s_waitcnt lgkmcnt(2)
    v_mfma_f32_16x16x32_bf16 v[160:163], v[76:79], v[108:111], v[160:163]
    s_waitcnt lgkmcnt(1)
    v_mfma_f32_16x16x32_bf16 v[160:163], v[80:83], v[112:115], v[160:163]
    s_waitcnt lgkmcnt(0)
    v_mfma_f32_16x16x32_bf16 v[160:163], v[84:87], v[116:119], v[160:163]
    v_mfma_f32_16x16x32_bf16 v[164:167], v[72:75], v[120:123], 0
    v_mfma_f32_16x16x32_bf16 v[164:167], v[76:79], v[124:127], v[164:167]
    v_mfma_f32_16x16x32_bf16 v[164:167], v[80:83], v[128:131], v[164:167]
    v_mfma_f32_16x16x32_bf16 v[164:167], v[84:87], v[132:135], v[164:167]
    v_mfma_f32_16x16x32_bf16 v[168:171], v[72:75], v[136:139], 0
    v_mfma_f32_16x16x32_bf16 v[168:171], v[76:79], v[140:143], v[168:171]
    v_mfma_f32_16x16x32_bf16 v[168:171], v[80:83], v[144:147], v[168:171]
    v_mfma_f32_16x16x32_bf16 v[168:171], v[84:87], v[148:151], v[168:171]
    s_cmp_eq_u32 s63, 1
    s_cbranch_scc1 L_gfin
    s_mov_b32 exec_hi, 0
    v_fmac_f32 v172, v160, v175
    v_bfi_b32 v172, s62, v102, v172
    global_store_dword v154, v172, s[30:31] sc1
    v_fmac_f32 v173, v164, v175
    v_bfi_b32 v173, s62, v102, v173
    global_store_dword v155, v173, s[30:31] sc1
    v_fmac_f32 v174, v168, v175
    v_bfi_b32 v174, s62, v102, v174
    global_store_dword v157, v174, s[30:31] sc1
    s_endpgm
L_gfin:
    v_add_u32 v102, 1, v102
    v_and_b32 v102, s62, v102
    s_add_u32 s63, s63, 1
    s_cmp_eq_u32 s63, 2
    s_cbranch_scc1 L_mid
L_cdone:
    s_endpgm
L_factor:
    s_cmp_eq_u32 s45, 22
    s_cbranch_scc0 L_hook2
    v_and_b32 v94, 8, v0
    v_add_u32 v94, v94, v3
L_p31:
    s_sub_u32 s44, s44, 1
    s_cbranch_scc1 L_exit
    ds_read_b32 v95, v3 offset:56
    s_waitcnt lgkmcnt(0)
    v_cmp_gt_i32 vcc, s56, v95
    s_cbranch_vccnz L_p31
    ds_read_b64 v[36:37], v94 offset:192
    s_add_u32 s57, s53, 6
    s_waitcnt lgkmcnt(0)
    v_sub_f32 v36, v92, v36
    v_mul_f32 v36, s55, v36
    v_exp_f32 v36, v36
    s_nop 0
    v_mul_f32 v99, v36, v37
    s_lshr_b32 s45, s41, 3
    s_add_u32 s45, s45, 2
    s_cmp_eq_u32 s45, s56
    s_cbranch_scc0 L_vtile
    s_cmp_eq_u32 s43, 3
    s_cbranch_scc1 L_vtile
    v_bfi_b32 v160, s62, v102, v160
    v_bfi_b32 v164, s62, v102, v164
    v_bfi_b32 v168, s62, v102, v168
    s_mov_b32 exec_hi, 0
    s_cmp_eq_u32 s42, 0
    s_cbranch_scc1 L_yafar
    global_store_dword v176, v160, s[30:31]
    global_store_dword v177, v164, s[30:31]
    global_store_dword v178, v168, s[30:31]
    s_mov_b32 exec_hi, -1
    s_branch L_vtile
L_yafar:
    global_store_dword v176, v160, s[30:31] sc1
    global_store_dword v177, v164, s[30:31] sc1
    global_store_dword v178, v168, s[30:31] sc1
    s_mov_b32 exec_hi, -1
    s_branch L_vtile
L_hook2:
    s_add_u32 s57, s53, 6
    s_cmp_eq_u32 s56, 1
    s_cbranch_scc1 L_vtile
    s_cmp_lt_u32 s41, 8
    s_cbranch_scc1 L_yadone
    s_cmp_eq_u32 s43, 3
    s_cbranch_scc1 L_yadone
    v_and_b32 v94, 1, v2
    v_lshl_add_u32 v94, v94, 3, v3
    ds_read_b64 v[38:39], v94 offset:208
L_ya:
    s_sub_u32 s44, s44, 1
    s_cbranch_scc1 L_exit
    global_load_dword v172, v176, s[30:31] sc1
    global_load_dword v173, v177, s[30:31] sc1
    global_load_dword v174, v178, s[30:31] sc1
    s_waitcnt vmcnt(0) lgkmcnt(0)
    v_xor_b32 v172, v102, v172
    v_xor_b32 v173, v102, v173
    v_xor_b32 v174, v102, v174
    v_or3_b32 v94, v172, v173, v174
    v_and_b32 v94, s62, v94
    v_cmp_ne_u32 vcc, 0, v94
    s_cbranch_vccnz L_ya
    v_mul_f32 v172, v172, v38
    v_mul_f32 v173, v173, v38
    v_mul_f32 v174, v174, v38
    v_mov_b32 v175, v39
L_yadone:
    v_add_u32 v102, 1, v102
    v_and_b32 v102, s62, v102
    s_branch L_vtile
L_control:
    s_lshr_b32 s54, s2, 3
    s_and_b32 s55, s2, 7
    s_mul_i32 s45, s55, 4864
    s_add_u32 s45, s45, 786432
    v_and_b32 v4, 31, v0
    v_lshl_add_u32 v4, v4, 3, s45
    s_lshl_b64 s[58:59], 1, s54
    s_cmp_lt_u32 s54, 8
    s_cselect_b32 s45, s54, s55
    s_mul_i32 s45, s45, 4864
    s_add_u32 s45, s45, 851968
    v_mov_b32 v12, s45
    s_mov_b32 s56, 0
    s_mov_b32 s52, 0x80000000
    s_mov_b32 s53, 0
    s_waitcnt vmcnt(0)
L_p33:
    s_sub_u32 s44, s44, 1
    s_cbranch_scc1 L_exit
    ds_read_b32 v5, v3 offset:52
    s_waitcnt lgkmcnt(0)
    v_cmp_gt_i32 vcc, 1, v5
    s_cbranch_vccnz L_p33
    ds_read_b32 v14, v3 offset:60
    ds_read_b32 v5, v3 offset:72
    ds_read_b32 v6, v3 offset:4864
    s_waitcnt lgkmcnt(0)
    v_readfirstlane_b32 s45, v5
    v_readfirstlane_b32 s51, v6
    s_cmp_eq_u32 s45, 0
    s_cbranch_scc1 L_cend
L_cloop:
    s_sub_u32 s44, s44, 1
    s_cbranch_scc1 L_exit
    ds_read_b32 v6, v3 offset:4864
    s_waitcnt lgkmcnt(0)
    v_readfirstlane_b32 s50, v6
    v_or_b32 v15, s52, v6
    s_mov_b64 exec, s[58:59]
    global_store_dwordx2 v4, v[14:15], s[30:31]
    s_mov_b64 exec, -1
    s_cmp_ge_i32 s50, 2088
    s_cbranch_scc1 L_cend
    global_load_dwordx2 v[6:7], v4, s[30:31] sc1
    s_cmp_ge_u32 s54, 8
    s_cbranch_scc1 L_cnold
    s_mov_b64 exec, 1
    global_load_dwordx2 v[10:11], v12, s[30:31] sc1
    s_mov_b64 exec, -1
L_cnold:
    s_add_u32 s46, s50, s51
    s_lshl_b32 s46, s46, 4
    s_mov_b32 s51, s50
    s_waitcnt vmcnt(0)
    v_cmp_ne_u32 vcc, v14, v6
    s_cbranch_vccnz L_cloop
    v_ashrrev_i32 v8, 20, v7
    v_cmp_eq_u32 vcc, 0xfffff800, v8
    s_nop 0
    v_add_u32_dpp v8, v8, v8 quad_perm:[1,0,3,2] row_mask:0xf bank_mask:0xf
    s_nop 1
    v_add_u32_dpp v8, v8, v8 quad_perm:[2,3,0,1] row_mask:0xf bank_mask:0xf
    s_nop 1
    v_add_u32_dpp v8, v8, v8 row_half_mirror row_mask:0xf bank_mask:0xf
    s_and_b32 s45, vcc_lo, 0xff
    s_cbranch_scc1 L_cnox
    v_readfirstlane_b32 s47, v8
    s_add_i32 s47, s47, 328
    s_lshl_b32 s47, s47, 2
    s_sub_u32 s46, s46, s47
L_cnox:
    v_and_b32 v7, 0xfff, v7
    s_nop 1
    v_add_u32_dpp v7, v7, v7 row_ror:1 row_mask:0xf bank_mask:0xf
    s_nop 1
    v_add_u32_dpp v7, v7, v7 row_ror:2 row_mask:0xf bank_mask:0xf
    s_nop 1
    v_add_u32_dpp v7, v7, v7 row_ror:4 row_mask:0xf bank_mask:0xf
    s_nop 1
    v_add_u32_dpp v7, v7, v7 row_ror:8 row_mask:0xf bank_mask:0xf
    v_mov_b32 v8, v7
    s_nop 1
    v_permlane16_swap_b32 v8, v7
    v_add_u32 v7, v8, v7
    v_subrev_u32 v8, s46, v7
    s_cmp_ge_i32 s50, 2008
    s_cselect_b32 s45, 1, 0
    v_lshlrev_b32 v8, s45, v8
    v_add_u32 v8, 128, v8
    v_ashrrev_i32 v8, 8, v8
    s_mov_b64 exec, 1
    ds_write_b32 v3, v8 offset:68
    s_mov_b64 exec, -1
    s_cmp_lt_u32 s54, 8
    s_cbranch_scc1 L_cwatch
    s_cmp_eq_u32 s54, 8
    s_cbranch_scc0 L_cloop
    s_sub_u32 s53, s53, 1
    s_cbranch_scc0 L_cloop
    s_mov_b32 s53, 11
    v_mov_b32 v15, v7
    s_mov_b64 exec, 1
    global_store_dwordx2 v12, v[14:15], s[30:31] sc1
    s_mov_b64 exec, -1
    s_branch L_cloop
L_cwatch:
    v_xor_b32 v10, v14, v10
    v_readfirstlane_b32 s47, v7
    v_readfirstlane_b32 s45, v11
    v_readfirstlane_b32 s48, v10
    s_cmp_lg_u32 s48, 0
    s_cbranch_scc1 L_cloop
    s_cmp_eq_u32 s45, s56
    s_cbranch_scc1 L_cloop
    s_mov_b32 s56, s45
    s_sub_i32 s45, s45, s47
    s_ashr_i32 s45, s45, 5
    s_max_i32 s45, s45, -200
    s_min_i32 s45, s45, 200
    s_lshl_b32 s52, s45, 20
    s_branch L_cloop
L_cend:
    s_endpgm
L_exit:
    s_endpgm
.section .rodata,"a"
.p2align 6
.amdhsa_kernel gated_mix__gqa_block_cached__gqa_block_cached__decode_kernel
  .amdhsa_next_free_vgpr 184
  .amdhsa_next_free_sgpr 100
  .amdhsa_accum_offset 184
  .amdhsa_group_segment_fixed_size 0
  .amdhsa_kernarg_size 112
  .amdhsa_user_sgpr_count 2
  .amdhsa_user_sgpr_kernarg_segment_ptr 1
  .amdhsa_system_sgpr_workgroup_id_x 1
  .amdhsa_float_denorm_mode_32 3
.end_amdhsa_kernel
```
